```python
import torch

def _softmax(x, axis=-1):
    return torch.softmax(x, dim=axis)
def _gelu(x):
    return torch.nn.functional.gelu(x, approximate="tanh")
def _silu(x):
    return torch.nn.functional.silu(x)
def _sigmoid(x):
    return torch.sigmoid(x)
def _layernorm(x, axis=-1, eps=1e-5):
    m = x.mean(dim=axis, keepdim=True)
    v = x.var(dim=axis, keepdim=True, unbiased=False)
    return (x - m) / torch.sqrt(v + eps)
def _scatter_add(tgt, idx, src, axis=0):
    return tgt.clone().index_add_(axis, idx, src)
def _segment_sum(src, seg, n):
    out = torch.zeros((n,) + src.shape[1:], dtype=src.dtype)
    return out.index_add_(0, seg, src)
def _pad(x, pw):
    flat = tuple(v for pair in reversed(pw) for v in pair)
    return torch.nn.functional.pad(x, flat)

kernel_name = 'standalone__deep_cross_xdeepfm__recsys'

def setup_inputs():

    _w = (lambda a: (lambda t: t.to(torch.bfloat16) if t.is_floating_point() else t)(torch.as_tensor(a)))
    B, F, D, L = 1024, 26, 128, 3
    V = min(100000, 100000)
    Din = F * D
    return {
        "idx": _w((lambda lo, hi, *s: torch.randint(lo, hi, s))(0, V, B, F).to(torch.int64)),
        "table": _w((lambda *s: torch.randn(*s, dtype=torch.bfloat16) * 0.8)(V, D)),
        "ws_cin": _w((lambda *s: torch.randn(*s, dtype=torch.bfloat16) * 0.2)(L, F, F, F) * (1.0 / F)),
        "w_cin_out": _w((lambda *s: torch.randn(*s, dtype=torch.bfloat16) * 0.2)(L * F) * ((L * F) ** -0.5)),
        "w_dnn1": _w((lambda *s: torch.randn(*s, dtype=torch.bfloat16) * 0.8)(Din, Din) * (Din ** -0.5)),
        "b_dnn1": _w((lambda *s: torch.randn(*s, dtype=torch.bfloat16) * 3.2)(Din) * 0.1),
        "w_dnn2": _w((lambda *s: torch.randn(*s, dtype=torch.bfloat16) * 0.2)(Din) * (Din ** -0.5)),
        "b_out": _w((lambda *s: torch.randn(*s, dtype=torch.bfloat16) * 0.2)(1)),
    }

def reference(idx, table, ws_cin, w_cin_out, w_dnn1, b_dnn1, w_dnn2, b_out):
    x0 = table[idx]
    B = x0.shape[0]
    L = ws_cin.shape[0]
    xk = x0
    pooled = []
    for l in range(L):
        xk = torch.einsum('bid,bjd,hij->bhd', xk, x0, ws_cin[l])
        pooled.append(xk.sum(axis=-1))
    p_plus = torch.stack(pooled, axis=1).reshape(B, -1)
    logit_cin = p_plus @ w_cin_out
    h = x0.reshape(B, -1)
    h = _gelu(h @ w_dnn1 + b_dnn1)
    logit_dnn = h @ w_dnn2
    return logit_cin + logit_dnn + b_out
```

```asm
; @launch grid=(256,1,1) block=(512,1,1) lds=163840
.amdgcn_target "amdgcn-amd-amdhsa--gfx950"
.text
.globl standalone__deep_cross_xdeepfm__recsys_kernel
.p2align 8
.type standalone__deep_cross_xdeepfm__recsys_kernel,@function
standalone__deep_cross_xdeepfm__recsys_kernel:
    s_cmp_ge_u32 s2, 256
    s_cbranch_scc1 L_end
    s_load_dwordx16 s[4:19], s[0:1], 0
    s_load_dwordx4 s[20:23], s[0:1], 64
    s_load_dwordx2 s[24:25], s[0:1], 80
    v_lshrrev_b32 v1, 6, v0
    v_and_b32 v0, 63, v0
    v_readfirstlane_b32 s60, v1
    s_and_b32 s66, s2, 7
    s_lshr_b32 s67, s2, 3
    s_mov_b32 s30, 106496
    s_mov_b32 s31, 0x20000
    s_mov_b32 s42, 6656
    s_mov_b32 s43, 0x20000
    s_mov_b32 s38, 22151168
    s_mov_b32 s39, 0x20000
    s_mov_b32 s34, 25600000
    s_mov_b32 s35, 0x20000
    s_mov_b32 s46, 6656
    s_mov_b32 s47, 0x20000
    s_mov_b32 s50, 268435456
    s_mov_b32 s51, 0x20000
    s_mov_b32 s54, 256
    s_mov_b32 s55, 0x20000
    s_mov_b32 s58, 2048
    s_mov_b32 s59, 0x20000
    s_mul_i32 s68, s66, 26
    s_add_u32 s68, s68, s67
    s_sub_u32 s68, s68, 6
    s_lshr_b32 s62, s68, 3
    s_and_b32 s61, s68, 7
    s_lshl_b32 s63, s61, 7
    s_lshl_b32 s64, s62, 7
    s_waitcnt lgkmcnt(0)
    s_mov_b32 s28, s4
    s_and_b32 s29, s5, 0xffff
    s_mov_b32 s40, s14
    s_and_b32 s41, s15, 0xffff
    s_mov_b32 s36, s12
    s_and_b32 s37, s13, 0xffff
    s_mov_b32 s32, s6
    s_and_b32 s33, s7, 0xffff
    s_mov_b32 s44, s16
    s_and_b32 s45, s17, 0xffff
    s_mov_b32 s48, s24
    s_and_b32 s49, s25, 0xffff
    s_mov_b32 s52, s22
    s_and_b32 s53, s23, 0xffff
    s_mov_b32 s56, s20
    s_and_b32 s57, s21, 0xffff
    s_cmp_lt_u32 s67, 6
    s_cbranch_scc1 L_cin
    s_cmp_ge_u32 s60, 4
    s_cbranch_scc1 L_loader
    s_and_b32 s66, s60, 1
    s_lshr_b32 s67, s60, 1
    s_lshl_b32 s68, s66, 6
    s_add_u32 s68, s68, s64
    s_lshl_b32 s68, s68, 1
    v_lshrrev_b32 v1, 4, v0
    v_lshlrev_b32 v2, 3, v1
    buffer_load_dwordx2 v[220:221], v2, s[40:43], s68 offen offset:0
    buffer_load_dwordx2 v[222:223], v2, s[40:43], s68 offen offset:32
    buffer_load_dwordx2 v[224:225], v2, s[40:43], s68 offen offset:64
    buffer_load_dwordx2 v[226:227], v2, s[40:43], s68 offen offset:96
    buffer_load_dwordx2 v[244:245], v2, s[44:47], s68 offen offset:0
    buffer_load_dwordx2 v[246:247], v2, s[44:47], s68 offen offset:32
    buffer_load_dwordx2 v[248:249], v2, s[44:47], s68 offen offset:64
    buffer_load_dwordx2 v[250:251], v2, s[44:47], s68 offen offset:96
    v_and_b32 v3, 15, v0
    s_lshl_b32 s69, s67, 13
    v_lshlrev_b32 v4, 7, v3
    v_add_u32 v4, s69, v4
    v_bfe_u32 v5, v3, 1, 3
    v_or_b32 v6, 0, v1
    v_xor_b32 v6, v6, v5
    v_lshl_add_u32 v208, v6, 4, v4
    v_add_u32 v210, 65536, v208
    v_or_b32 v6, 4, v1
    v_xor_b32 v6, v6, v5
    v_lshl_add_u32 v209, v6, 4, v4
    v_add_u32 v211, 65536, v209
    v_bfe_u32 v3, v0, 2, 2
    v_lshlrev_b32 v4, 3, v1
    v_add_u32 v4, v4, v3
    v_lshlrev_b32 v4, 8, v4
    v_and_b32 v5, 1, v0
    v_lshl_add_u32 v4, v5, 3, v4
    v_add_u32 v4, 16384, v4
    v_bfe_u32 v5, v0, 4, 1
    v_lshl_add_u32 v3, v5, 2, v3
    v_bfe_u32 v5, v0, 1, 1
    s_lshl_b32 s68, s66, 2
    s_add_u32 s69, s68, 0
    v_xor_b32 v6, s69, v3
    v_lshl_add_u32 v6, v6, 1, v5
    v_lshl_add_u32 v212, v6, 4, v4
    v_add_u32 v216, 65536, v212
    s_add_u32 s69, s68, 1
    v_xor_b32 v6, s69, v3
    v_lshl_add_u32 v6, v6, 1, v5
    v_lshl_add_u32 v213, v6, 4, v4
    v_add_u32 v217, 65536, v213
    s_add_u32 s69, s68, 2
    v_xor_b32 v6, s69, v3
    v_lshl_add_u32 v6, v6, 1, v5
    v_lshl_add_u32 v214, v6, 4, v4
    v_add_u32 v218, 65536, v214
    s_add_u32 s69, s68, 3
    v_xor_b32 v6, s69, v3
    v_lshl_add_u32 v6, v6, 1, v5
    v_lshl_add_u32 v215, v6, 4, v4
    v_add_u32 v219, 65536, v215
    s_waitcnt vmcnt(4)
    v_lshlrev_b32 v16, 16, v220
    v_and_b32 v17, 0xffff0000, v220
    v_lshlrev_b32 v20, 16, v220
    v_and_b32 v21, 0xffff0000, v220
    v_lshlrev_b32 v24, 16, v220
    v_and_b32 v25, 0xffff0000, v220
    v_lshlrev_b32 v28, 16, v220
    v_and_b32 v29, 0xffff0000, v220
    v_lshlrev_b32 v18, 16, v221
    v_and_b32 v19, 0xffff0000, v221
    v_lshlrev_b32 v22, 16, v221
    v_and_b32 v23, 0xffff0000, v221
    v_lshlrev_b32 v26, 16, v221
    v_and_b32 v27, 0xffff0000, v221
    v_lshlrev_b32 v30, 16, v221
    v_and_b32 v31, 0xffff0000, v221
    v_lshlrev_b32 v32, 16, v222
    v_and_b32 v33, 0xffff0000, v222
    v_lshlrev_b32 v36, 16, v222
    v_and_b32 v37, 0xffff0000, v222
    v_lshlrev_b32 v40, 16, v222
    v_and_b32 v41, 0xffff0000, v222
    v_lshlrev_b32 v44, 16, v222
    v_and_b32 v45, 0xffff0000, v222
    v_lshlrev_b32 v34, 16, v223
    v_and_b32 v35, 0xffff0000, v223
    v_lshlrev_b32 v38, 16, v223
    v_and_b32 v39, 0xffff0000, v223
    v_lshlrev_b32 v42, 16, v223
    v_and_b32 v43, 0xffff0000, v223
    v_lshlrev_b32 v46, 16, v223
    v_and_b32 v47, 0xffff0000, v223
    v_lshlrev_b32 v48, 16, v224
    v_and_b32 v49, 0xffff0000, v224
    v_lshlrev_b32 v52, 16, v224
    v_and_b32 v53, 0xffff0000, v224
    v_lshlrev_b32 v56, 16, v224
    v_and_b32 v57, 0xffff0000, v224
    v_lshlrev_b32 v60, 16, v224
    v_and_b32 v61, 0xffff0000, v224
    v_lshlrev_b32 v50, 16, v225
    v_and_b32 v51, 0xffff0000, v225
    v_lshlrev_b32 v54, 16, v225
    v_and_b32 v55, 0xffff0000, v225
    v_lshlrev_b32 v58, 16, v225
    v_and_b32 v59, 0xffff0000, v225
    v_lshlrev_b32 v62, 16, v225
    v_and_b32 v63, 0xffff0000, v225
    v_lshlrev_b32 v64, 16, v226
    v_and_b32 v65, 0xffff0000, v226
    v_lshlrev_b32 v68, 16, v226
    v_and_b32 v69, 0xffff0000, v226
    v_lshlrev_b32 v72, 16, v226
    v_and_b32 v73, 0xffff0000, v226
    v_lshlrev_b32 v76, 16, v226
    v_and_b32 v77, 0xffff0000, v226
    v_lshlrev_b32 v66, 16, v227
    v_and_b32 v67, 0xffff0000, v227
    v_lshlrev_b32 v70, 16, v227
    v_and_b32 v71, 0xffff0000, v227
    v_lshlrev_b32 v74, 16, v227
    v_and_b32 v75, 0xffff0000, v227
    v_lshlrev_b32 v78, 16, v227
    v_and_b32 v79, 0xffff0000, v227
    v_mov_b32 v220, 0xc0135761
    v_mov_b32 v222, 0xbdd2d3e8
    v_mov_b32 v221, 0xc0135761
    v_mov_b32 v223, 0xbdd2d3e8
    v_mov_b32 v224, 0
    v_mov_b32 v225, 0
    v_mov_b32 v226, 0
    v_mov_b32 v227, 0
    v_mov_b32 v228, 0
    v_mov_b32 v229, 0
    v_mov_b32 v230, 0
    v_mov_b32 v231, 0
    s_lshl1_add_u32 s68, s62, s66
    s_lshl1_add_u32 s68, s68, s67
    s_lshl_b32 s68, s68, 8
    s_mul_i32 s69, s61, 28672
    s_add_u32 s68, s68, s69
    v_lshlrev_b32 v1, 2, v0
    s_barrier
    ds_read_b64_tr_b16 v[80:81], v212 offset:0
    ds_read_b64_tr_b16 v[82:83], v212 offset:1024
    ds_read_b128 v[96:99], v208 offset:0
    ds_read_b64_tr_b16 v[112:113], v212 offset:8192
    ds_read_b64_tr_b16 v[114:115], v212 offset:9216
    ds_read_b128 v[128:131], v209 offset:0
    ds_read_b128 v[100:103], v208 offset:2048
    ds_read_b128 v[132:135], v209 offset:2048
    ds_read_b128 v[104:107], v208 offset:4096
    ds_read_b128 v[136:139], v209 offset:4096
    ds_read_b128 v[108:111], v208 offset:6144
    ds_read_b128 v[140:143], v209 offset:6144
    ds_read_b64_tr_b16 v[84:85], v213 offset:0
    ds_read_b64_tr_b16 v[86:87], v213 offset:1024
    ds_read_b64_tr_b16 v[116:117], v213 offset:8192
    ds_read_b64_tr_b16 v[118:119], v213 offset:9216
    ds_read_b64_tr_b16 v[88:89], v214 offset:0
    ds_read_b64_tr_b16 v[90:91], v214 offset:1024
    ds_read_b64_tr_b16 v[120:121], v214 offset:8192
    ds_read_b64_tr_b16 v[122:123], v214 offset:9216
    ds_read_b64_tr_b16 v[92:93], v215 offset:0
    ds_read_b64_tr_b16 v[94:95], v215 offset:1024
    ds_read_b64_tr_b16 v[124:125], v215 offset:8192
    ds_read_b64_tr_b16 v[126:127], v215 offset:9216
    s_mov_b32 s66, 0
L_mloop:
    s_waitcnt lgkmcnt(0)
    s_barrier
    v_mfma_f32_16x16x32_bf16 v[16:19], v[80:83], v[96:99], v[16:19]
    ds_read_b64_tr_b16 v[144:145], v212 offset:32768
    v_mfma_f32_16x16x32_bf16 v[16:19], v[112:115], v[128:131], v[16:19]
    ds_read_b64_tr_b16 v[146:147], v212 offset:33792
    v_mfma_f32_16x16x32_bf16 v[20:23], v[80:83], v[100:103], v[20:23]
    ds_read_b128 v[160:163], v208 offset:32768
    v_mfma_f32_16x16x32_bf16 v[20:23], v[112:115], v[132:135], v[20:23]
    ds_read_b64_tr_b16 v[176:177], v212 offset:40960
    v_mfma_f32_16x16x32_bf16 v[24:27], v[80:83], v[104:107], v[24:27]
    ds_read_b64_tr_b16 v[178:179], v212 offset:41984
    v_mfma_f32_16x16x32_bf16 v[24:27], v[112:115], v[136:139], v[24:27]
    ds_read_b128 v[192:195], v209 offset:32768
    v_mfma_f32_16x16x32_bf16 v[28:31], v[80:83], v[108:111], v[28:31]
    ds_read_b128 v[164:167], v208 offset:34816
    v_mfma_f32_16x16x32_bf16 v[28:31], v[112:115], v[140:143], v[28:31]
    ds_read_b128 v[196:199], v209 offset:34816
    v_mfma_f32_16x16x32_bf16 v[44:47], v[84:87], v[108:111], v[44:47]
    ds_read_b128 v[168:171], v208 offset:36864
    v_mfma_f32_16x16x32_bf16 v[44:47], v[116:119], v[140:143], v[44:47]
    ds_read_b128 v[200:203], v209 offset:36864
    v_mfma_f32_16x16x32_bf16 v[40:43], v[84:87], v[104:107], v[40:43]
    ds_read_b128 v[172:175], v208 offset:38912
    v_mfma_f32_16x16x32_bf16 v[40:43], v[116:119], v[136:139], v[40:43]
    ds_read_b128 v[204:207], v209 offset:38912
    v_mfma_f32_16x16x32_bf16 v[36:39], v[84:87], v[100:103], v[36:39]
    ds_read_b64_tr_b16 v[148:149], v213 offset:32768
    v_mfma_f32_16x16x32_bf16 v[36:39], v[116:119], v[132:135], v[36:39]
    ds_read_b64_tr_b16 v[150:151], v213 offset:33792
    v_mfma_f32_16x16x32_bf16 v[32:35], v[84:87], v[96:99], v[32:35]
    ds_read_b64_tr_b16 v[180:181], v213 offset:40960
    v_mfma_f32_16x16x32_bf16 v[32:35], v[116:119], v[128:131], v[32:35]
    ds_read_b64_tr_b16 v[182:183], v213 offset:41984
    v_mfma_f32_16x16x32_bf16 v[48:51], v[88:91], v[96:99], v[48:51]
    ds_read_b64_tr_b16 v[152:153], v214 offset:32768
    v_mfma_f32_16x16x32_bf16 v[48:51], v[120:123], v[128:131], v[48:51]
    ds_read_b64_tr_b16 v[154:155], v214 offset:33792
    v_mfma_f32_16x16x32_bf16 v[52:55], v[88:91], v[100:103], v[52:55]
    ds_read_b64_tr_b16 v[184:185], v214 offset:40960
    v_mfma_f32_16x16x32_bf16 v[52:55], v[120:123], v[132:135], v[52:55]
    ds_read_b64_tr_b16 v[186:187], v214 offset:41984
    v_mfma_f32_16x16x32_bf16 v[56:59], v[88:91], v[104:107], v[56:59]
    ds_read_b64_tr_b16 v[156:157], v215 offset:32768
    v_mfma_f32_16x16x32_bf16 v[56:59], v[120:123], v[136:139], v[56:59]
    ds_read_b64_tr_b16 v[158:159], v215 offset:33792
    v_mfma_f32_16x16x32_bf16 v[60:63], v[88:91], v[108:111], v[60:63]
    ds_read_b64_tr_b16 v[188:189], v215 offset:40960
    v_mfma_f32_16x16x32_bf16 v[60:63], v[120:123], v[140:143], v[60:63]
    ds_read_b64_tr_b16 v[190:191], v215 offset:41984
    v_mfma_f32_16x16x32_bf16 v[76:79], v[92:95], v[108:111], v[76:79]
    v_mfma_f32_16x16x32_bf16 v[76:79], v[124:127], v[140:143], v[76:79]
    v_mfma_f32_16x16x32_bf16 v[72:75], v[92:95], v[104:107], v[72:75]
    v_mfma_f32_16x16x32_bf16 v[72:75], v[124:127], v[136:139], v[72:75]
    v_mfma_f32_16x16x32_bf16 v[68:71], v[92:95], v[100:103], v[68:71]
    v_mfma_f32_16x16x32_bf16 v[68:71], v[124:127], v[132:135], v[68:71]
    v_mfma_f32_16x16x32_bf16 v[64:67], v[92:95], v[96:99], v[64:67]
    v_mfma_f32_16x16x32_bf16 v[64:67], v[124:127], v[128:131], v[64:67]
    s_waitcnt lgkmcnt(0)
    s_barrier
    v_mfma_f32_16x16x32_bf16 v[16:19], v[144:147], v[160:163], v[16:19]
    ds_read_b64_tr_b16 v[80:81], v216 offset:0
    v_mfma_f32_16x16x32_bf16 v[16:19], v[176:179], v[192:195], v[16:19]
    ds_read_b64_tr_b16 v[82:83], v216 offset:1024
    v_mfma_f32_16x16x32_bf16 v[20:23], v[144:147], v[164:167], v[20:23]
    ds_read_b128 v[96:99], v210 offset:0
    v_mfma_f32_16x16x32_bf16 v[20:23], v[176:179], v[196:199], v[20:23]
    ds_read_b64_tr_b16 v[112:113], v216 offset:8192
    v_mfma_f32_16x16x32_bf16 v[24:27], v[144:147], v[168:171], v[24:27]
    ds_read_b64_tr_b16 v[114:115], v216 offset:9216
    v_mfma_f32_16x16x32_bf16 v[24:27], v[176:179], v[200:203], v[24:27]
    ds_read_b128 v[128:131], v211 offset:0
    v_mfma_f32_16x16x32_bf16 v[28:31], v[144:147], v[172:175], v[28:31]
    ds_read_b128 v[100:103], v210 offset:2048
    v_mfma_f32_16x16x32_bf16 v[28:31], v[176:179], v[204:207], v[28:31]
    ds_read_b128 v[132:135], v211 offset:2048
    v_mfma_f32_16x16x32_bf16 v[44:47], v[148:151], v[172:175], v[44:47]
    ds_read_b128 v[104:107], v210 offset:4096
    v_mfma_f32_16x16x32_bf16 v[44:47], v[180:183], v[204:207], v[44:47]
    ds_read_b128 v[136:139], v211 offset:4096
    v_mfma_f32_16x16x32_bf16 v[40:43], v[148:151], v[168:171], v[40:43]
    ds_read_b128 v[108:111], v210 offset:6144
    v_mfma_f32_16x16x32_bf16 v[40:43], v[180:183], v[200:203], v[40:43]
    ds_read_b128 v[140:143], v211 offset:6144
    v_mfma_f32_16x16x32_bf16 v[36:39], v[148:151], v[164:167], v[36:39]
    ds_read_b64_tr_b16 v[84:85], v217 offset:0
    v_mfma_f32_16x16x32_bf16 v[36:39], v[180:183], v[196:199], v[36:39]
    ds_read_b64_tr_b16 v[86:87], v217 offset:1024
    v_mfma_f32_16x16x32_bf16 v[32:35], v[148:151], v[160:163], v[32:35]
    ds_read_b64_tr_b16 v[116:117], v217 offset:8192
    v_mfma_f32_16x16x32_bf16 v[32:35], v[180:183], v[192:195], v[32:35]
    ds_read_b64_tr_b16 v[118:119], v217 offset:9216
    v_mfma_f32_16x16x32_bf16 v[48:51], v[152:155], v[160:163], v[48:51]
    ds_read_b64_tr_b16 v[88:89], v218 offset:0
    v_mfma_f32_16x16x32_bf16 v[48:51], v[184:187], v[192:195], v[48:51]
    ds_read_b64_tr_b16 v[90:91], v218 offset:1024
    v_mfma_f32_16x16x32_bf16 v[52:55], v[152:155], v[164:167], v[52:55]
    ds_read_b64_tr_b16 v[120:121], v218 offset:8192
    v_mfma_f32_16x16x32_bf16 v[52:55], v[184:187], v[196:199], v[52:55]
    ds_read_b64_tr_b16 v[122:123], v218 offset:9216
    v_mfma_f32_16x16x32_bf16 v[56:59], v[152:155], v[168:171], v[56:59]
    ds_read_b64_tr_b16 v[92:93], v219 offset:0
    v_mfma_f32_16x16x32_bf16 v[56:59], v[184:187], v[200:203], v[56:59]
    ds_read_b64_tr_b16 v[94:95], v219 offset:1024
    v_mfma_f32_16x16x32_bf16 v[60:63], v[152:155], v[172:175], v[60:63]
    ds_read_b64_tr_b16 v[124:125], v219 offset:8192
    v_mfma_f32_16x16x32_bf16 v[60:63], v[184:187], v[204:207], v[60:63]
    ds_read_b64_tr_b16 v[126:127], v219 offset:9216
    v_mfma_f32_16x16x32_bf16 v[76:79], v[156:159], v[172:175], v[76:79]
    v_mfma_f32_16x16x32_bf16 v[76:79], v[188:191], v[204:207], v[76:79]
    v_mfma_f32_16x16x32_bf16 v[72:75], v[156:159], v[168:171], v[72:75]
    v_mfma_f32_16x16x32_bf16 v[72:75], v[188:191], v[200:203], v[72:75]
    v_mfma_f32_16x16x32_bf16 v[68:71], v[156:159], v[164:167], v[68:71]
    v_mfma_f32_16x16x32_bf16 v[68:71], v[188:191], v[196:199], v[68:71]
    v_mfma_f32_16x16x32_bf16 v[64:67], v[156:159], v[160:163], v[64:67]
    v_mfma_f32_16x16x32_bf16 v[64:67], v[188:191], v[192:195], v[64:67]
    s_waitcnt lgkmcnt(0)
    s_barrier
    v_mfma_f32_16x16x32_bf16 v[16:19], v[80:83], v[96:99], v[16:19]
    ds_read_b64_tr_b16 v[144:145], v212 offset:0
    v_mfma_f32_16x16x32_bf16 v[16:19], v[112:115], v[128:131], v[16:19]
    ds_read_b64_tr_b16 v[146:147], v212 offset:1024
    v_mfma_f32_16x16x32_bf16 v[20:23], v[80:83], v[100:103], v[20:23]
    ds_read_b128 v[160:163], v208 offset:0
    v_mfma_f32_16x16x32_bf16 v[20:23], v[112:115], v[132:135], v[20:23]
    ds_read_b64_tr_b16 v[176:177], v212 offset:8192
    v_mfma_f32_16x16x32_bf16 v[24:27], v[80:83], v[104:107], v[24:27]
    ds_read_b64_tr_b16 v[178:179], v212 offset:9216
    v_mfma_f32_16x16x32_bf16 v[24:27], v[112:115], v[136:139], v[24:27]
    ds_read_b128 v[192:195], v209 offset:0
    v_mfma_f32_16x16x32_bf16 v[28:31], v[80:83], v[108:111], v[28:31]
    ds_read_b128 v[164:167], v208 offset:2048
    v_mfma_f32_16x16x32_bf16 v[28:31], v[112:115], v[140:143], v[28:31]
    ds_read_b128 v[196:199], v209 offset:2048
    v_mfma_f32_16x16x32_bf16 v[44:47], v[84:87], v[108:111], v[44:47]
    ds_read_b128 v[168:171], v208 offset:4096
    v_mfma_f32_16x16x32_bf16 v[44:47], v[116:119], v[140:143], v[44:47]
    ds_read_b128 v[200:203], v209 offset:4096
    v_mfma_f32_16x16x32_bf16 v[40:43], v[84:87], v[104:107], v[40:43]
    ds_read_b128 v[172:175], v208 offset:6144
    v_mfma_f32_16x16x32_bf16 v[40:43], v[116:119], v[136:139], v[40:43]
    ds_read_b128 v[204:207], v209 offset:6144
    v_mfma_f32_16x16x32_bf16 v[36:39], v[84:87], v[100:103], v[36:39]
    ds_read_b64_tr_b16 v[148:149], v213 offset:0
    v_mfma_f32_16x16x32_bf16 v[36:39], v[116:119], v[132:135], v[36:39]
    ds_read_b64_tr_b16 v[150:151], v213 offset:1024
    v_mfma_f32_16x16x32_bf16 v[32:35], v[84:87], v[96:99], v[32:35]
    ds_read_b64_tr_b16 v[180:181], v213 offset:8192
    v_mfma_f32_16x16x32_bf16 v[32:35], v[116:119], v[128:131], v[32:35]
    ds_read_b64_tr_b16 v[182:183], v213 offset:9216
    v_mfma_f32_16x16x32_bf16 v[48:51], v[88:91], v[96:99], v[48:51]
    ds_read_b64_tr_b16 v[152:153], v214 offset:0
    v_mfma_f32_16x16x32_bf16 v[48:51], v[120:123], v[128:131], v[48:51]
    ds_read_b64_tr_b16 v[154:155], v214 offset:1024
    v_mfma_f32_16x16x32_bf16 v[52:55], v[88:91], v[100:103], v[52:55]
    ds_read_b64_tr_b16 v[184:185], v214 offset:8192
    v_mfma_f32_16x16x32_bf16 v[52:55], v[120:123], v[132:135], v[52:55]
    ds_read_b64_tr_b16 v[186:187], v214 offset:9216
    v_mfma_f32_16x16x32_bf16 v[56:59], v[88:91], v[104:107], v[56:59]
    ds_read_b64_tr_b16 v[156:157], v215 offset:0
    v_mfma_f32_16x16x32_bf16 v[56:59], v[120:123], v[136:139], v[56:59]
    ds_read_b64_tr_b16 v[158:159], v215 offset:1024
    v_mfma_f32_16x16x32_bf16 v[60:63], v[88:91], v[108:111], v[60:63]
    ds_read_b64_tr_b16 v[188:189], v215 offset:8192
    v_mfma_f32_16x16x32_bf16 v[60:63], v[120:123], v[140:143], v[60:63]
    ds_read_b64_tr_b16 v[190:191], v215 offset:9216
    v_mfma_f32_16x16x32_bf16 v[76:79], v[92:95], v[108:111], v[76:79]
    v_mfma_f32_16x16x32_bf16 v[76:79], v[124:127], v[140:143], v[76:79]
    v_mfma_f32_16x16x32_bf16 v[72:75], v[92:95], v[104:107], v[72:75]
    v_mfma_f32_16x16x32_bf16 v[72:75], v[124:127], v[136:139], v[72:75]
    v_mfma_f32_16x16x32_bf16 v[68:71], v[92:95], v[100:103], v[68:71]
    v_mfma_f32_16x16x32_bf16 v[68:71], v[124:127], v[132:135], v[68:71]
    v_mfma_f32_16x16x32_bf16 v[64:67], v[92:95], v[96:99], v[64:67]
    v_mfma_f32_16x16x32_bf16 v[64:67], v[124:127], v[128:131], v[64:67]
    s_waitcnt lgkmcnt(0)
    s_barrier
    v_mfma_f32_16x16x32_bf16 v[16:19], v[144:147], v[160:163], v[16:19]
    ds_read_b64_tr_b16 v[80:81], v212 offset:32768
    v_mfma_f32_16x16x32_bf16 v[16:19], v[176:179], v[192:195], v[16:19]
    ds_read_b64_tr_b16 v[82:83], v212 offset:33792
    v_mfma_f32_16x16x32_bf16 v[20:23], v[144:147], v[164:167], v[20:23]
    ds_read_b128 v[96:99], v208 offset:32768
    v_mfma_f32_16x16x32_bf16 v[20:23], v[176:179], v[196:199], v[20:23]
    ds_read_b64_tr_b16 v[112:113], v212 offset:40960
    v_mfma_f32_16x16x32_bf16 v[24:27], v[144:147], v[168:171], v[24:27]
    ds_read_b64_tr_b16 v[114:115], v212 offset:41984
    v_mfma_f32_16x16x32_bf16 v[24:27], v[176:179], v[200:203], v[24:27]
    ds_read_b128 v[128:131], v209 offset:32768
    v_mfma_f32_16x16x32_bf16 v[28:31], v[144:147], v[172:175], v[28:31]
    ds_read_b128 v[100:103], v208 offset:34816
    v_mfma_f32_16x16x32_bf16 v[28:31], v[176:179], v[204:207], v[28:31]
    ds_read_b128 v[132:135], v209 offset:34816
    v_mfma_f32_16x16x32_bf16 v[44:47], v[148:151], v[172:175], v[44:47]
    ds_read_b128 v[104:107], v208 offset:36864
    v_mfma_f32_16x16x32_bf16 v[44:47], v[180:183], v[204:207], v[44:47]
    ds_read_b128 v[136:139], v209 offset:36864
    v_mfma_f32_16x16x32_bf16 v[40:43], v[148:151], v[168:171], v[40:43]
    ds_read_b128 v[108:111], v208 offset:38912
    v_mfma_f32_16x16x32_bf16 v[40:43], v[180:183], v[200:203], v[40:43]
    ds_read_b128 v[140:143], v209 offset:38912
    v_mfma_f32_16x16x32_bf16 v[36:39], v[148:151], v[164:167], v[36:39]
    ds_read_b64_tr_b16 v[84:85], v213 offset:32768
    v_mfma_f32_16x16x32_bf16 v[36:39], v[180:183], v[196:199], v[36:39]
    ds_read_b64_tr_b16 v[86:87], v213 offset:33792
    v_mfma_f32_16x16x32_bf16 v[32:35], v[148:151], v[160:163], v[32:35]
    ds_read_b64_tr_b16 v[116:117], v213 offset:40960
    v_mfma_f32_16x16x32_bf16 v[32:35], v[180:183], v[192:195], v[32:35]
    ds_read_b64_tr_b16 v[118:119], v213 offset:41984
    v_mfma_f32_16x16x32_bf16 v[48:51], v[152:155], v[160:163], v[48:51]
    ds_read_b64_tr_b16 v[88:89], v214 offset:32768
    v_mfma_f32_16x16x32_bf16 v[48:51], v[184:187], v[192:195], v[48:51]
    ds_read_b64_tr_b16 v[90:91], v214 offset:33792
    v_mfma_f32_16x16x32_bf16 v[52:55], v[152:155], v[164:167], v[52:55]
    ds_read_b64_tr_b16 v[120:121], v214 offset:40960
    v_mfma_f32_16x16x32_bf16 v[52:55], v[184:187], v[196:199], v[52:55]
    ds_read_b64_tr_b16 v[122:123], v214 offset:41984
    v_mfma_f32_16x16x32_bf16 v[56:59], v[152:155], v[168:171], v[56:59]
    ds_read_b64_tr_b16 v[92:93], v215 offset:32768
    v_mfma_f32_16x16x32_bf16 v[56:59], v[184:187], v[200:203], v[56:59]
    ds_read_b64_tr_b16 v[94:95], v215 offset:33792
    v_mfma_f32_16x16x32_bf16 v[60:63], v[152:155], v[172:175], v[60:63]
    ds_read_b64_tr_b16 v[124:125], v215 offset:40960
    v_mfma_f32_16x16x32_bf16 v[60:63], v[184:187], v[204:207], v[60:63]
    ds_read_b64_tr_b16 v[126:127], v215 offset:41984
    v_mfma_f32_16x16x32_bf16 v[76:79], v[156:159], v[172:175], v[76:79]
    v_mfma_f32_16x16x32_bf16 v[76:79], v[188:191], v[204:207], v[76:79]
    v_mfma_f32_16x16x32_bf16 v[72:75], v[156:159], v[168:171], v[72:75]
    v_mfma_f32_16x16x32_bf16 v[72:75], v[188:191], v[200:203], v[72:75]
    v_mfma_f32_16x16x32_bf16 v[68:71], v[156:159], v[164:167], v[68:71]
    v_mfma_f32_16x16x32_bf16 v[68:71], v[188:191], v[196:199], v[68:71]
    v_mfma_f32_16x16x32_bf16 v[64:67], v[156:159], v[160:163], v[64:67]
    v_mfma_f32_16x16x32_bf16 v[64:67], v[188:191], v[192:195], v[64:67]
    s_waitcnt lgkmcnt(0)
    s_barrier
    v_mfma_f32_16x16x32_bf16 v[16:19], v[80:83], v[96:99], v[16:19]
    ds_read_b64_tr_b16 v[144:145], v216 offset:0
    v_mfma_f32_16x16x32_bf16 v[16:19], v[112:115], v[128:131], v[16:19]
    ds_read_b64_tr_b16 v[146:147], v216 offset:1024
    v_mfma_f32_16x16x32_bf16 v[20:23], v[80:83], v[100:103], v[20:23]
    ds_read_b128 v[160:163], v210 offset:0
    v_mfma_f32_16x16x32_bf16 v[20:23], v[112:115], v[132:135], v[20:23]
    ds_read_b64_tr_b16 v[176:177], v216 offset:8192
    v_mfma_f32_16x16x32_bf16 v[24:27], v[80:83], v[104:107], v[24:27]
    ds_read_b64_tr_b16 v[178:179], v216 offset:9216
    v_mfma_f32_16x16x32_bf16 v[24:27], v[112:115], v[136:139], v[24:27]
    ds_read_b128 v[192:195], v211 offset:0
    v_mfma_f32_16x16x32_bf16 v[28:31], v[80:83], v[108:111], v[28:31]
    ds_read_b128 v[164:167], v210 offset:2048
    v_mfma_f32_16x16x32_bf16 v[28:31], v[112:115], v[140:143], v[28:31]
    ds_read_b128 v[196:199], v211 offset:2048
    v_mfma_f32_16x16x32_bf16 v[44:47], v[84:87], v[108:111], v[44:47]
    ds_read_b128 v[168:171], v210 offset:4096
    v_mfma_f32_16x16x32_bf16 v[44:47], v[116:119], v[140:143], v[44:47]
    ds_read_b128 v[200:203], v211 offset:4096
    v_mfma_f32_16x16x32_bf16 v[40:43], v[84:87], v[104:107], v[40:43]
    ds_read_b128 v[172:175], v210 offset:6144
    v_mfma_f32_16x16x32_bf16 v[40:43], v[116:119], v[136:139], v[40:43]
    ds_read_b128 v[204:207], v211 offset:6144
    v_mfma_f32_16x16x32_bf16 v[36:39], v[84:87], v[100:103], v[36:39]
    ds_read_b64_tr_b16 v[148:149], v217 offset:0
    v_mfma_f32_16x16x32_bf16 v[36:39], v[116:119], v[132:135], v[36:39]
    ds_read_b64_tr_b16 v[150:151], v217 offset:1024
    v_mfma_f32_16x16x32_bf16 v[32:35], v[84:87], v[96:99], v[32:35]
    ds_read_b64_tr_b16 v[180:181], v217 offset:8192
    v_mfma_f32_16x16x32_bf16 v[32:35], v[116:119], v[128:131], v[32:35]
    ds_read_b64_tr_b16 v[182:183], v217 offset:9216
    v_mfma_f32_16x16x32_bf16 v[48:51], v[88:91], v[96:99], v[48:51]
    ds_read_b64_tr_b16 v[152:153], v218 offset:0
    v_mfma_f32_16x16x32_bf16 v[48:51], v[120:123], v[128:131], v[48:51]
    ds_read_b64_tr_b16 v[154:155], v218 offset:1024
    v_mfma_f32_16x16x32_bf16 v[52:55], v[88:91], v[100:103], v[52:55]
    ds_read_b64_tr_b16 v[184:185], v218 offset:8192
    v_mfma_f32_16x16x32_bf16 v[52:55], v[120:123], v[132:135], v[52:55]
    ds_read_b64_tr_b16 v[186:187], v218 offset:9216
    v_mfma_f32_16x16x32_bf16 v[56:59], v[88:91], v[104:107], v[56:59]
    ds_read_b64_tr_b16 v[156:157], v219 offset:0
    v_mfma_f32_16x16x32_bf16 v[56:59], v[120:123], v[136:139], v[56:59]
    ds_read_b64_tr_b16 v[158:159], v219 offset:1024
    v_mfma_f32_16x16x32_bf16 v[60:63], v[88:91], v[108:111], v[60:63]
    ds_read_b64_tr_b16 v[188:189], v219 offset:8192
    v_mfma_f32_16x16x32_bf16 v[60:63], v[120:123], v[140:143], v[60:63]
    ds_read_b64_tr_b16 v[190:191], v219 offset:9216
    v_mfma_f32_16x16x32_bf16 v[76:79], v[92:95], v[108:111], v[76:79]
    v_mfma_f32_16x16x32_bf16 v[76:79], v[124:127], v[140:143], v[76:79]
    v_mfma_f32_16x16x32_bf16 v[72:75], v[92:95], v[104:107], v[72:75]
    v_mfma_f32_16x16x32_bf16 v[72:75], v[124:127], v[136:139], v[72:75]
    v_mfma_f32_16x16x32_bf16 v[68:71], v[92:95], v[100:103], v[68:71]
    v_mfma_f32_16x16x32_bf16 v[68:71], v[124:127], v[132:135], v[68:71]
    v_mfma_f32_16x16x32_bf16 v[64:67], v[92:95], v[96:99], v[64:67]
    v_mfma_f32_16x16x32_bf16 v[64:67], v[124:127], v[128:131], v[64:67]
    s_waitcnt lgkmcnt(0)
    s_barrier
    v_mfma_f32_16x16x32_bf16 v[16:19], v[144:147], v[160:163], v[16:19]
    ds_read_b64_tr_b16 v[80:81], v212 offset:0
    v_mfma_f32_16x16x32_bf16 v[16:19], v[176:179], v[192:195], v[16:19]
    ds_read_b64_tr_b16 v[82:83], v212 offset:1024
    s_add_u32 s66, s66, 1
    s_cmp_lg_u32 s66, 8
    v_mfma_f32_16x16x32_bf16 v[20:23], v[144:147], v[164:167], v[20:23]
    ds_read_b128 v[96:99], v208 offset:0
    v_mfma_f32_16x16x32_bf16 v[20:23], v[176:179], v[196:199], v[20:23]
    ds_read_b64_tr_b16 v[112:113], v212 offset:8192
    v_mfma_f32_16x16x32_bf16 v[24:27], v[144:147], v[168:171], v[24:27]
    ds_read_b64_tr_b16 v[114:115], v212 offset:9216
    v_mfma_f32_16x16x32_bf16 v[24:27], v[176:179], v[200:203], v[24:27]
    ds_read_b128 v[128:131], v209 offset:0
    v_mfma_f32_16x16x32_bf16 v[28:31], v[144:147], v[172:175], v[28:31]
    ds_read_b128 v[100:103], v208 offset:2048
    v_mfma_f32_16x16x32_bf16 v[28:31], v[176:179], v[204:207], v[28:31]
    ds_read_b128 v[132:135], v209 offset:2048
    v_mfma_f32_16x16x32_bf16 v[44:47], v[148:151], v[172:175], v[44:47]
    ds_read_b128 v[104:107], v208 offset:4096
    v_mfma_f32_16x16x32_bf16 v[44:47], v[180:183], v[204:207], v[44:47]
    ds_read_b128 v[136:139], v209 offset:4096
    v_mfma_f32_16x16x32_bf16 v[40:43], v[148:151], v[168:171], v[40:43]
    ds_read_b128 v[108:111], v208 offset:6144
    v_mfma_f32_16x16x32_bf16 v[40:43], v[180:183], v[200:203], v[40:43]
    ds_read_b128 v[140:143], v209 offset:6144
    v_mfma_f32_16x16x32_bf16 v[36:39], v[148:151], v[164:167], v[36:39]
    ds_read_b64_tr_b16 v[84:85], v213 offset:0
    v_mfma_f32_16x16x32_bf16 v[36:39], v[180:183], v[196:199], v[36:39]
    ds_read_b64_tr_b16 v[86:87], v213 offset:1024
    v_mfma_f32_16x16x32_bf16 v[32:35], v[148:151], v[160:163], v[32:35]
    ds_read_b64_tr_b16 v[116:117], v213 offset:8192
    v_mfma_f32_16x16x32_bf16 v[32:35], v[180:183], v[192:195], v[32:35]
    ds_read_b64_tr_b16 v[118:119], v213 offset:9216
    v_mfma_f32_16x16x32_bf16 v[48:51], v[152:155], v[160:163], v[48:51]
    ds_read_b64_tr_b16 v[88:89], v214 offset:0
    v_mfma_f32_16x16x32_bf16 v[48:51], v[184:187], v[192:195], v[48:51]
    ds_read_b64_tr_b16 v[90:91], v214 offset:1024
    v_mfma_f32_16x16x32_bf16 v[52:55], v[152:155], v[164:167], v[52:55]
    ds_read_b64_tr_b16 v[120:121], v214 offset:8192
    v_mfma_f32_16x16x32_bf16 v[52:55], v[184:187], v[196:199], v[52:55]
    ds_read_b64_tr_b16 v[122:123], v214 offset:9216
    v_mfma_f32_16x16x32_bf16 v[56:59], v[152:155], v[168:171], v[56:59]
    ds_read_b64_tr_b16 v[92:93], v215 offset:0
    v_mfma_f32_16x16x32_bf16 v[56:59], v[184:187], v[200:203], v[56:59]
    ds_read_b64_tr_b16 v[94:95], v215 offset:1024
    v_mfma_f32_16x16x32_bf16 v[60:63], v[152:155], v[172:175], v[60:63]
    ds_read_b64_tr_b16 v[124:125], v215 offset:8192
    v_mfma_f32_16x16x32_bf16 v[60:63], v[184:187], v[204:207], v[60:63]
    ds_read_b64_tr_b16 v[126:127], v215 offset:9216
    v_mfma_f32_16x16x32_bf16 v[76:79], v[156:159], v[172:175], v[76:79]
    v_mfma_f32_16x16x32_bf16 v[76:79], v[188:191], v[204:207], v[76:79]
    v_mfma_f32_16x16x32_bf16 v[72:75], v[156:159], v[168:171], v[72:75]
    v_mfma_f32_16x16x32_bf16 v[72:75], v[188:191], v[200:203], v[72:75]
    v_mfma_f32_16x16x32_bf16 v[68:71], v[156:159], v[164:167], v[68:71]
    v_mfma_f32_16x16x32_bf16 v[68:71], v[188:191], v[196:199], v[68:71]
    v_mfma_f32_16x16x32_bf16 v[64:67], v[156:159], v[160:163], v[64:67]
    v_mfma_f32_16x16x32_bf16 v[64:67], v[188:191], v[192:195], v[64:67]
    s_cbranch_scc1 L_mloop
    s_waitcnt lgkmcnt(0)
    s_barrier
    v_mfma_f32_16x16x32_bf16 v[16:19], v[80:83], v[96:99], v[16:19]
    ds_read_b64_tr_b16 v[144:145], v212 offset:32768
    v_mfma_f32_16x16x32_bf16 v[16:19], v[112:115], v[128:131], v[16:19]
    ds_read_b64_tr_b16 v[146:147], v212 offset:33792
    v_mfma_f32_16x16x32_bf16 v[20:23], v[80:83], v[100:103], v[20:23]
    ds_read_b128 v[160:163], v208 offset:32768
    v_mfma_f32_16x16x32_bf16 v[20:23], v[112:115], v[132:135], v[20:23]
    ds_read_b64_tr_b16 v[176:177], v212 offset:40960
    v_mfma_f32_16x16x32_bf16 v[24:27], v[80:83], v[104:107], v[24:27]
    ds_read_b64_tr_b16 v[178:179], v212 offset:41984
    v_mfma_f32_16x16x32_bf16 v[24:27], v[112:115], v[136:139], v[24:27]
    ds_read_b128 v[192:195], v209 offset:32768
    v_mfma_f32_16x16x32_bf16 v[28:31], v[80:83], v[108:111], v[28:31]
    ds_read_b128 v[164:167], v208 offset:34816
    v_mfma_f32_16x16x32_bf16 v[28:31], v[112:115], v[140:143], v[28:31]
    ds_read_b128 v[196:199], v209 offset:34816
    v_mfma_f32_16x16x32_bf16 v[44:47], v[84:87], v[108:111], v[44:47]
    ds_read_b128 v[168:171], v208 offset:36864
    v_mfma_f32_16x16x32_bf16 v[44:47], v[116:119], v[140:143], v[44:47]
    ds_read_b128 v[200:203], v209 offset:36864
    v_mfma_f32_16x16x32_bf16 v[40:43], v[84:87], v[104:107], v[40:43]
    ds_read_b128 v[172:175], v208 offset:38912
    v_mfma_f32_16x16x32_bf16 v[40:43], v[116:119], v[136:139], v[40:43]
    ds_read_b128 v[204:207], v209 offset:38912
    v_mfma_f32_16x16x32_bf16 v[36:39], v[84:87], v[100:103], v[36:39]
    ds_read_b64_tr_b16 v[148:149], v213 offset:32768
    v_mfma_f32_16x16x32_bf16 v[36:39], v[116:119], v[132:135], v[36:39]
    ds_read_b64_tr_b16 v[150:151], v213 offset:33792
    v_mfma_f32_16x16x32_bf16 v[32:35], v[84:87], v[96:99], v[32:35]
    ds_read_b64_tr_b16 v[180:181], v213 offset:40960
    v_mfma_f32_16x16x32_bf16 v[32:35], v[116:119], v[128:131], v[32:35]
    ds_read_b64_tr_b16 v[182:183], v213 offset:41984
    v_mfma_f32_16x16x32_bf16 v[48:51], v[88:91], v[96:99], v[48:51]
    ds_read_b64_tr_b16 v[152:153], v214 offset:32768
    v_mfma_f32_16x16x32_bf16 v[48:51], v[120:123], v[128:131], v[48:51]
    ds_read_b64_tr_b16 v[154:155], v214 offset:33792
    v_mfma_f32_16x16x32_bf16 v[52:55], v[88:91], v[100:103], v[52:55]
    ds_read_b64_tr_b16 v[184:185], v214 offset:40960
    v_mfma_f32_16x16x32_bf16 v[52:55], v[120:123], v[132:135], v[52:55]
    ds_read_b64_tr_b16 v[186:187], v214 offset:41984
    v_mfma_f32_16x16x32_bf16 v[56:59], v[88:91], v[104:107], v[56:59]
    ds_read_b64_tr_b16 v[156:157], v215 offset:32768
    v_mfma_f32_16x16x32_bf16 v[56:59], v[120:123], v[136:139], v[56:59]
    ds_read_b64_tr_b16 v[158:159], v215 offset:33792
    v_mfma_f32_16x16x32_bf16 v[60:63], v[88:91], v[108:111], v[60:63]
    ds_read_b64_tr_b16 v[188:189], v215 offset:40960
    v_mfma_f32_16x16x32_bf16 v[60:63], v[120:123], v[140:143], v[60:63]
    ds_read_b64_tr_b16 v[190:191], v215 offset:41984
    v_mfma_f32_16x16x32_bf16 v[76:79], v[92:95], v[108:111], v[76:79]
    v_mfma_f32_16x16x32_bf16 v[76:79], v[124:127], v[140:143], v[76:79]
    v_mfma_f32_16x16x32_bf16 v[72:75], v[92:95], v[104:107], v[72:75]
    v_mfma_f32_16x16x32_bf16 v[72:75], v[124:127], v[136:139], v[72:75]
    v_mfma_f32_16x16x32_bf16 v[68:71], v[92:95], v[100:103], v[68:71]
    v_mfma_f32_16x16x32_bf16 v[68:71], v[124:127], v[132:135], v[68:71]
    v_mfma_f32_16x16x32_bf16 v[64:67], v[92:95], v[96:99], v[64:67]
    v_mfma_f32_16x16x32_bf16 v[64:67], v[124:127], v[128:131], v[64:67]
    s_waitcnt lgkmcnt(0)
    s_barrier
    v_mfma_f32_16x16x32_bf16 v[16:19], v[144:147], v[160:163], v[16:19]
    ds_read_b64_tr_b16 v[80:81], v216 offset:0
    v_mfma_f32_16x16x32_bf16 v[16:19], v[176:179], v[192:195], v[16:19]
    ds_read_b64_tr_b16 v[82:83], v216 offset:1024
    v_mfma_f32_16x16x32_bf16 v[20:23], v[144:147], v[164:167], v[20:23]
    ds_read_b128 v[96:99], v210 offset:0
    v_mfma_f32_16x16x32_bf16 v[20:23], v[176:179], v[196:199], v[20:23]
    ds_read_b64_tr_b16 v[112:113], v216 offset:8192
    v_mfma_f32_16x16x32_bf16 v[24:27], v[144:147], v[168:171], v[24:27]
    ds_read_b64_tr_b16 v[114:115], v216 offset:9216
    v_mfma_f32_16x16x32_bf16 v[24:27], v[176:179], v[200:203], v[24:27]
    ds_read_b128 v[128:131], v211 offset:0
    v_mfma_f32_16x16x32_bf16 v[28:31], v[144:147], v[172:175], v[28:31]
    ds_read_b128 v[100:103], v210 offset:2048
    v_mfma_f32_16x16x32_bf16 v[28:31], v[176:179], v[204:207], v[28:31]
    ds_read_b128 v[132:135], v211 offset:2048
    v_mfma_f32_16x16x32_bf16 v[44:47], v[148:151], v[172:175], v[44:47]
    ds_read_b128 v[104:107], v210 offset:4096
    v_mfma_f32_16x16x32_bf16 v[44:47], v[180:183], v[204:207], v[44:47]
    ds_read_b128 v[136:139], v211 offset:4096
    v_mfma_f32_16x16x32_bf16 v[40:43], v[148:151], v[168:171], v[40:43]
    ds_read_b128 v[108:111], v210 offset:6144
    v_mfma_f32_16x16x32_bf16 v[40:43], v[180:183], v[200:203], v[40:43]
    ds_read_b128 v[140:143], v211 offset:6144
    v_mfma_f32_16x16x32_bf16 v[36:39], v[148:151], v[164:167], v[36:39]
    ds_read_b64_tr_b16 v[84:85], v217 offset:0
    v_mfma_f32_16x16x32_bf16 v[36:39], v[180:183], v[196:199], v[36:39]
    ds_read_b64_tr_b16 v[86:87], v217 offset:1024
    v_mfma_f32_16x16x32_bf16 v[32:35], v[148:151], v[160:163], v[32:35]
    ds_read_b64_tr_b16 v[116:117], v217 offset:8192
    v_mfma_f32_16x16x32_bf16 v[32:35], v[180:183], v[192:195], v[32:35]
    ds_read_b64_tr_b16 v[118:119], v217 offset:9216
    v_mfma_f32_16x16x32_bf16 v[48:51], v[152:155], v[160:163], v[48:51]
    ds_read_b64_tr_b16 v[88:89], v218 offset:0
    v_mfma_f32_16x16x32_bf16 v[48:51], v[184:187], v[192:195], v[48:51]
    ds_read_b64_tr_b16 v[90:91], v218 offset:1024
    v_mfma_f32_16x16x32_bf16 v[52:55], v[152:155], v[164:167], v[52:55]
    ds_read_b64_tr_b16 v[120:121], v218 offset:8192
    v_mfma_f32_16x16x32_bf16 v[52:55], v[184:187], v[196:199], v[52:55]
    ds_read_b64_tr_b16 v[122:123], v218 offset:9216
    v_mfma_f32_16x16x32_bf16 v[56:59], v[152:155], v[168:171], v[56:59]
    ds_read_b64_tr_b16 v[92:93], v219 offset:0
    v_mfma_f32_16x16x32_bf16 v[56:59], v[184:187], v[200:203], v[56:59]
    ds_read_b64_tr_b16 v[94:95], v219 offset:1024
    v_mfma_f32_16x16x32_bf16 v[60:63], v[152:155], v[172:175], v[60:63]
    ds_read_b64_tr_b16 v[124:125], v219 offset:8192
    v_mfma_f32_16x16x32_bf16 v[60:63], v[184:187], v[204:207], v[60:63]
    ds_read_b64_tr_b16 v[126:127], v219 offset:9216
    v_mfma_f32_16x16x32_bf16 v[76:79], v[156:159], v[172:175], v[76:79]
    v_mfma_f32_16x16x32_bf16 v[76:79], v[188:191], v[204:207], v[76:79]
    v_mfma_f32_16x16x32_bf16 v[72:75], v[156:159], v[168:171], v[72:75]
    v_mfma_f32_16x16x32_bf16 v[72:75], v[188:191], v[200:203], v[72:75]
    v_mfma_f32_16x16x32_bf16 v[68:71], v[156:159], v[164:167], v[68:71]
    v_mfma_f32_16x16x32_bf16 v[68:71], v[188:191], v[196:199], v[68:71]
    v_mfma_f32_16x16x32_bf16 v[64:67], v[156:159], v[160:163], v[64:67]
    v_mfma_f32_16x16x32_bf16 v[64:67], v[188:191], v[192:195], v[64:67]
    s_waitcnt lgkmcnt(0)
    s_barrier
    v_mfma_f32_16x16x32_bf16 v[16:19], v[80:83], v[96:99], v[16:19]
    ds_read_b64_tr_b16 v[144:145], v212 offset:0
    v_mfma_f32_16x16x32_bf16 v[16:19], v[112:115], v[128:131], v[16:19]
    ds_read_b64_tr_b16 v[146:147], v212 offset:1024
    v_mfma_f32_16x16x32_bf16 v[20:23], v[80:83], v[100:103], v[20:23]
    ds_read_b128 v[160:163], v208 offset:0
    v_mfma_f32_16x16x32_bf16 v[20:23], v[112:115], v[132:135], v[20:23]
    ds_read_b64_tr_b16 v[176:177], v212 offset:8192
    v_mfma_f32_16x16x32_bf16 v[24:27], v[80:83], v[104:107], v[24:27]
    ds_read_b64_tr_b16 v[178:179], v212 offset:9216
    v_mfma_f32_16x16x32_bf16 v[24:27], v[112:115], v[136:139], v[24:27]
    ds_read_b128 v[192:195], v209 offset:0
    v_mfma_f32_16x16x32_bf16 v[28:31], v[80:83], v[108:111], v[28:31]
    ds_read_b128 v[164:167], v208 offset:2048
    v_mfma_f32_16x16x32_bf16 v[28:31], v[112:115], v[140:143], v[28:31]
    ds_read_b128 v[196:199], v209 offset:2048
    v_mfma_f32_16x16x32_bf16 v[44:47], v[84:87], v[108:111], v[44:47]
    ds_read_b128 v[168:171], v208 offset:4096
    v_mfma_f32_16x16x32_bf16 v[44:47], v[116:119], v[140:143], v[44:47]
    ds_read_b128 v[200:203], v209 offset:4096
    v_mfma_f32_16x16x32_bf16 v[40:43], v[84:87], v[104:107], v[40:43]
    ds_read_b128 v[172:175], v208 offset:6144
    v_mfma_f32_16x16x32_bf16 v[40:43], v[116:119], v[136:139], v[40:43]
    ds_read_b128 v[204:207], v209 offset:6144
    v_mfma_f32_16x16x32_bf16 v[36:39], v[84:87], v[100:103], v[36:39]
    ds_read_b64_tr_b16 v[148:149], v213 offset:0
    v_mfma_f32_16x16x32_bf16 v[36:39], v[116:119], v[132:135], v[36:39]
    ds_read_b64_tr_b16 v[150:151], v213 offset:1024
    v_mfma_f32_16x16x32_bf16 v[32:35], v[84:87], v[96:99], v[32:35]
    ds_read_b64_tr_b16 v[180:181], v213 offset:8192
    v_mfma_f32_16x16x32_bf16 v[32:35], v[116:119], v[128:131], v[32:35]
    ds_read_b64_tr_b16 v[182:183], v213 offset:9216
    v_mfma_f32_16x16x32_bf16 v[48:51], v[88:91], v[96:99], v[48:51]
    ds_read_b64_tr_b16 v[152:153], v214 offset:0
    v_mfma_f32_16x16x32_bf16 v[48:51], v[120:123], v[128:131], v[48:51]
    ds_read_b64_tr_b16 v[154:155], v214 offset:1024
    v_mfma_f32_16x16x32_bf16 v[52:55], v[88:91], v[100:103], v[52:55]
    ds_read_b64_tr_b16 v[184:185], v214 offset:8192
    v_mfma_f32_16x16x32_bf16 v[52:55], v[120:123], v[132:135], v[52:55]
    ds_read_b64_tr_b16 v[186:187], v214 offset:9216
    v_mfma_f32_16x16x32_bf16 v[56:59], v[88:91], v[104:107], v[56:59]
    ds_read_b64_tr_b16 v[156:157], v215 offset:0
    v_mfma_f32_16x16x32_bf16 v[56:59], v[120:123], v[136:139], v[56:59]
    ds_read_b64_tr_b16 v[158:159], v215 offset:1024
    v_mfma_f32_16x16x32_bf16 v[60:63], v[88:91], v[108:111], v[60:63]
    ds_read_b64_tr_b16 v[188:189], v215 offset:8192
    v_mfma_f32_16x16x32_bf16 v[60:63], v[120:123], v[140:143], v[60:63]
    ds_read_b64_tr_b16 v[190:191], v215 offset:9216
    v_mfma_f32_16x16x32_bf16 v[76:79], v[92:95], v[108:111], v[76:79]
    v_mfma_f32_16x16x32_bf16 v[76:79], v[124:127], v[140:143], v[76:79]
    v_mfma_f32_16x16x32_bf16 v[72:75], v[92:95], v[104:107], v[72:75]
    v_mfma_f32_16x16x32_bf16 v[72:75], v[124:127], v[136:139], v[72:75]
    v_mfma_f32_16x16x32_bf16 v[68:71], v[92:95], v[100:103], v[68:71]
    v_mfma_f32_16x16x32_bf16 v[68:71], v[124:127], v[132:135], v[68:71]
    v_mfma_f32_16x16x32_bf16 v[64:67], v[92:95], v[96:99], v[64:67]
    v_mfma_f32_16x16x32_bf16 v[64:67], v[124:127], v[128:131], v[64:67]
    s_waitcnt lgkmcnt(15)
    v_mfma_f32_16x16x32_bf16 v[16:19], v[144:147], v[160:163], v[16:19]
    s_waitcnt lgkmcnt(15)
    v_mfma_f32_16x16x32_bf16 v[16:19], v[176:179], v[192:195], v[16:19]
    s_waitcnt vmcnt(0)
    v_lshlrev_b32 v80, 16, v244
    v_and_b32 v81, 0xffff0000, v244
    v_lshlrev_b32 v82, 16, v245
    v_and_b32 v83, 0xffff0000, v245
    v_lshlrev_b32 v84, 16, v246
    v_and_b32 v85, 0xffff0000, v246
    v_lshlrev_b32 v86, 16, v247
    v_and_b32 v87, 0xffff0000, v247
    v_lshlrev_b32 v88, 16, v248
    v_and_b32 v89, 0xffff0000, v248
    v_lshlrev_b32 v90, 16, v249
    v_and_b32 v91, 0xffff0000, v249
    v_lshlrev_b32 v92, 16, v250
    v_and_b32 v93, 0xffff0000, v250
    v_lshlrev_b32 v94, 16, v251
    v_and_b32 v95, 0xffff0000, v251
    s_waitcnt lgkmcnt(15)
    v_mfma_f32_16x16x32_bf16 v[20:23], v[144:147], v[164:167], v[20:23]
    s_waitcnt lgkmcnt(15)
    v_mfma_f32_16x16x32_bf16 v[20:23], v[176:179], v[196:199], v[20:23]
    s_waitcnt lgkmcnt(15)
    v_mfma_f32_16x16x32_bf16 v[24:27], v[144:147], v[168:171], v[24:27]
    s_waitcnt lgkmcnt(14)
    v_mfma_f32_16x16x32_bf16 v[24:27], v[176:179], v[200:203], v[24:27]
    s_waitcnt lgkmcnt(13)
    v_mfma_f32_16x16x32_bf16 v[28:31], v[144:147], v[172:175], v[28:31]
    s_waitcnt lgkmcnt(12)
    v_mfma_f32_16x16x32_bf16 v[28:31], v[176:179], v[204:207], v[28:31]
    s_waitcnt lgkmcnt(10)
    v_mfma_f32_16x16x32_bf16 v[44:47], v[148:151], v[172:175], v[44:47]
    s_waitcnt lgkmcnt(8)
    v_mfma_f32_16x16x32_bf16 v[44:47], v[180:183], v[204:207], v[44:47]
    v_mfma_f32_16x16x32_bf16 v[40:43], v[148:151], v[168:171], v[40:43]
    v_mfma_f32_16x16x32_bf16 v[40:43], v[180:183], v[200:203], v[40:43]
    v_mfma_f32_16x16x32_bf16 v[36:39], v[148:151], v[164:167], v[36:39]
    v_mfma_f32_16x16x32_bf16 v[36:39], v[180:183], v[196:199], v[36:39]
    v_mfma_f32_16x16x32_bf16 v[32:35], v[148:151], v[160:163], v[32:35]
    v_mfma_f32_16x16x32_bf16 v[32:35], v[180:183], v[192:195], v[32:35]
    s_waitcnt lgkmcnt(6)
    v_mfma_f32_16x16x32_bf16 v[48:51], v[152:155], v[160:163], v[48:51]
    s_waitcnt lgkmcnt(4)
    v_mfma_f32_16x16x32_bf16 v[48:51], v[184:187], v[192:195], v[48:51]
    v_mfma_f32_16x16x32_bf16 v[52:55], v[152:155], v[164:167], v[52:55]
    v_mfma_f32_16x16x32_bf16 v[52:55], v[184:187], v[196:199], v[52:55]
    v_mfma_f32_16x16x32_bf16 v[56:59], v[152:155], v[168:171], v[56:59]
    v_mfma_f32_16x16x32_bf16 v[56:59], v[184:187], v[200:203], v[56:59]
    v_mfma_f32_16x16x32_bf16 v[60:63], v[152:155], v[172:175], v[60:63]
    v_mfma_f32_16x16x32_bf16 v[60:63], v[184:187], v[204:207], v[60:63]
    s_waitcnt lgkmcnt(2)
    v_mfma_f32_16x16x32_bf16 v[76:79], v[156:159], v[172:175], v[76:79]
    s_waitcnt lgkmcnt(0)
    v_mfma_f32_16x16x32_bf16 v[76:79], v[188:191], v[204:207], v[76:79]
    v_mfma_f32_16x16x32_bf16 v[72:75], v[156:159], v[168:171], v[72:75]
    v_mfma_f32_16x16x32_bf16 v[72:75], v[188:191], v[200:203], v[72:75]
    v_mfma_f32_16x16x32_bf16 v[68:71], v[156:159], v[164:167], v[68:71]
    v_mfma_f32_16x16x32_bf16 v[68:71], v[188:191], v[196:199], v[68:71]
    v_mfma_f32_16x16x32_bf16 v[64:67], v[156:159], v[160:163], v[64:67]
    v_mfma_f32_16x16x32_bf16 v[64:67], v[188:191], v[192:195], v[64:67]
    s_nop 3
    v_pk_mul_f32 v[232:233], v[16:17], v[16:17]
    v_pk_mul_f32 v[234:235], v[18:19], v[18:19]
    v_pk_mul_f32 v[236:237], v[20:21], v[20:21]
    v_pk_mul_f32 v[238:239], v[22:23], v[22:23]
    v_pk_fma_f32 v[232:233], v[232:233], v[222:223], v[220:221]
    v_pk_fma_f32 v[234:235], v[234:235], v[222:223], v[220:221]
    v_pk_fma_f32 v[236:237], v[236:237], v[222:223], v[220:221]
    v_pk_fma_f32 v[238:239], v[238:239], v[222:223], v[220:221]
    v_pk_mul_f32 v[232:233], v[232:233], v[16:17]
    v_pk_mul_f32 v[234:235], v[234:235], v[18:19]
    v_pk_mul_f32 v[236:237], v[236:237], v[20:21]
    v_pk_mul_f32 v[238:239], v[238:239], v[22:23]
    v_exp_f32 v232, v232
    v_exp_f32 v233, v233
    v_exp_f32 v234, v234
    v_exp_f32 v235, v235
    v_exp_f32 v236, v236
    v_exp_f32 v237, v237
    v_exp_f32 v238, v238
    v_exp_f32 v239, v239
    v_pk_mul_f32 v[16:17], v[16:17], v[80:81]
    v_pk_mul_f32 v[18:19], v[18:19], v[82:83]
    v_pk_mul_f32 v[20:21], v[20:21], v[80:81]
    v_pk_mul_f32 v[22:23], v[22:23], v[82:83]
    v_pk_add_f32 v[232:233], v[232:233], 1.0 op_sel_hi:[1,0]
    v_pk_add_f32 v[234:235], v[234:235], 1.0 op_sel_hi:[1,0]
    v_pk_add_f32 v[236:237], v[236:237], 1.0 op_sel_hi:[1,0]
    v_pk_add_f32 v[238:239], v[238:239], 1.0 op_sel_hi:[1,0]
    v_rcp_f32 v232, v232
    v_rcp_f32 v233, v233
    v_rcp_f32 v234, v234
    v_rcp_f32 v235, v235
    v_rcp_f32 v236, v236
    v_rcp_f32 v237, v237
    v_rcp_f32 v238, v238
    v_rcp_f32 v239, v239
    s_nop 0
    v_pk_fma_f32 v[224:225], v[16:17], v[232:233], v[224:225]
    v_pk_fma_f32 v[224:225], v[18:19], v[234:235], v[224:225]
    v_pk_fma_f32 v[226:227], v[20:21], v[236:237], v[226:227]
    v_pk_fma_f32 v[226:227], v[22:23], v[238:239], v[226:227]
    v_pk_mul_f32 v[232:233], v[24:25], v[24:25]
    v_pk_mul_f32 v[234:235], v[26:27], v[26:27]
    v_pk_mul_f32 v[236:237], v[28:29], v[28:29]
    v_pk_mul_f32 v[238:239], v[30:31], v[30:31]
    v_pk_fma_f32 v[232:233], v[232:233], v[222:223], v[220:221]
    v_pk_fma_f32 v[234:235], v[234:235], v[222:223], v[220:221]
    v_pk_fma_f32 v[236:237], v[236:237], v[222:223], v[220:221]
    v_pk_fma_f32 v[238:239], v[238:239], v[222:223], v[220:221]
    v_pk_mul_f32 v[232:233], v[232:233], v[24:25]
    v_pk_mul_f32 v[234:235], v[234:235], v[26:27]
    v_pk_mul_f32 v[236:237], v[236:237], v[28:29]
    v_pk_mul_f32 v[238:239], v[238:239], v[30:31]
    v_exp_f32 v232, v232
    v_exp_f32 v233, v233
    v_exp_f32 v234, v234
    v_exp_f32 v235, v235
    v_exp_f32 v236, v236
    v_exp_f32 v237, v237
    v_exp_f32 v238, v238
    v_exp_f32 v239, v239
    v_pk_mul_f32 v[24:25], v[24:25], v[80:81]
    v_pk_mul_f32 v[26:27], v[26:27], v[82:83]
    v_pk_mul_f32 v[28:29], v[28:29], v[80:81]
    v_pk_mul_f32 v[30:31], v[30:31], v[82:83]
    v_pk_add_f32 v[232:233], v[232:233], 1.0 op_sel_hi:[1,0]
    v_pk_add_f32 v[234:235], v[234:235], 1.0 op_sel_hi:[1,0]
    v_pk_add_f32 v[236:237], v[236:237], 1.0 op_sel_hi:[1,0]
    v_pk_add_f32 v[238:239], v[238:239], 1.0 op_sel_hi:[1,0]
    v_rcp_f32 v232, v232
    v_rcp_f32 v233, v233
    v_rcp_f32 v234, v234
    v_rcp_f32 v235, v235
    v_rcp_f32 v236, v236
    v_rcp_f32 v237, v237
    v_rcp_f32 v238, v238
    v_rcp_f32 v239, v239
    s_nop 0
    v_pk_fma_f32 v[228:229], v[24:25], v[232:233], v[228:229]
    v_pk_fma_f32 v[228:229], v[26:27], v[234:235], v[228:229]
    v_pk_fma_f32 v[230:231], v[28:29], v[236:237], v[230:231]
    v_pk_fma_f32 v[230:231], v[30:31], v[238:239], v[230:231]
    v_pk_mul_f32 v[232:233], v[44:45], v[44:45]
    v_pk_mul_f32 v[234:235], v[46:47], v[46:47]
    v_pk_mul_f32 v[236:237], v[40:41], v[40:41]
    v_pk_mul_f32 v[238:239], v[42:43], v[42:43]
    v_pk_fma_f32 v[232:233], v[232:233], v[222:223], v[220:221]
    v_pk_fma_f32 v[234:235], v[234:235], v[222:223], v[220:221]
    v_pk_fma_f32 v[236:237], v[236:237], v[222:223], v[220:221]
    v_pk_fma_f32 v[238:239], v[238:239], v[222:223], v[220:221]
    v_pk_mul_f32 v[232:233], v[232:233], v[44:45]
    v_pk_mul_f32 v[234:235], v[234:235], v[46:47]
    v_pk_mul_f32 v[236:237], v[236:237], v[40:41]
    v_pk_mul_f32 v[238:239], v[238:239], v[42:43]
    v_exp_f32 v232, v232
    v_exp_f32 v233, v233
    v_exp_f32 v234, v234
    v_exp_f32 v235, v235
    v_exp_f32 v236, v236
    v_exp_f32 v237, v237
    v_exp_f32 v238, v238
    v_exp_f32 v239, v239
    v_pk_mul_f32 v[44:45], v[44:45], v[84:85]
    v_pk_mul_f32 v[46:47], v[46:47], v[86:87]
    v_pk_mul_f32 v[40:41], v[40:41], v[84:85]
    v_pk_mul_f32 v[42:43], v[42:43], v[86:87]
    v_pk_add_f32 v[232:233], v[232:233], 1.0 op_sel_hi:[1,0]
    v_pk_add_f32 v[234:235], v[234:235], 1.0 op_sel_hi:[1,0]
    v_pk_add_f32 v[236:237], v[236:237], 1.0 op_sel_hi:[1,0]
    v_pk_add_f32 v[238:239], v[238:239], 1.0 op_sel_hi:[1,0]
    v_rcp_f32 v232, v232
    v_rcp_f32 v233, v233
    v_rcp_f32 v234, v234
    v_rcp_f32 v235, v235
    v_rcp_f32 v236, v236
    v_rcp_f32 v237, v237
    v_rcp_f32 v238, v238
    v_rcp_f32 v239, v239
    s_nop 0
    v_pk_fma_f32 v[230:231], v[44:45], v[232:233], v[230:231]
    v_pk_fma_f32 v[230:231], v[46:47], v[234:235], v[230:231]
    v_pk_fma_f32 v[228:229], v[40:41], v[236:237], v[228:229]
    v_pk_fma_f32 v[228:229], v[42:43], v[238:239], v[228:229]
    v_pk_mul_f32 v[232:233], v[36:37], v[36:37]
    v_pk_mul_f32 v[234:235], v[38:39], v[38:39]
    v_pk_mul_f32 v[236:237], v[32:33], v[32:33]
    v_pk_mul_f32 v[238:239], v[34:35], v[34:35]
    v_pk_fma_f32 v[232:233], v[232:233], v[222:223], v[220:221]
    v_pk_fma_f32 v[234:235], v[234:235], v[222:223], v[220:221]
    v_pk_fma_f32 v[236:237], v[236:237], v[222:223], v[220:221]
    v_pk_fma_f32 v[238:239], v[238:239], v[222:223], v[220:221]
    v_pk_mul_f32 v[232:233], v[232:233], v[36:37]
    v_pk_mul_f32 v[234:235], v[234:235], v[38:39]
    v_pk_mul_f32 v[236:237], v[236:237], v[32:33]
    v_pk_mul_f32 v[238:239], v[238:239], v[34:35]
    v_exp_f32 v232, v232
    v_exp_f32 v233, v233
    v_exp_f32 v234, v234
    v_exp_f32 v235, v235
    v_exp_f32 v236, v236
    v_exp_f32 v237, v237
    v_exp_f32 v238, v238
    v_exp_f32 v239, v239
    v_pk_mul_f32 v[36:37], v[36:37], v[84:85]
    v_pk_mul_f32 v[38:39], v[38:39], v[86:87]
    v_pk_mul_f32 v[32:33], v[32:33], v[84:85]
    v_pk_mul_f32 v[34:35], v[34:35], v[86:87]
    v_pk_add_f32 v[232:233], v[232:233], 1.0 op_sel_hi:[1,0]
    v_pk_add_f32 v[234:235], v[234:235], 1.0 op_sel_hi:[1,0]
    v_pk_add_f32 v[236:237], v[236:237], 1.0 op_sel_hi:[1,0]
    v_pk_add_f32 v[238:239], v[238:239], 1.0 op_sel_hi:[1,0]
    v_rcp_f32 v232, v232
    v_rcp_f32 v233, v233
    v_rcp_f32 v234, v234
    v_rcp_f32 v235, v235
    v_rcp_f32 v236, v236
    v_rcp_f32 v237, v237
    v_rcp_f32 v238, v238
    v_rcp_f32 v239, v239
    s_nop 0
    v_pk_fma_f32 v[226:227], v[36:37], v[232:233], v[226:227]
    v_pk_fma_f32 v[226:227], v[38:39], v[234:235], v[226:227]
    v_pk_fma_f32 v[224:225], v[32:33], v[236:237], v[224:225]
    v_pk_fma_f32 v[224:225], v[34:35], v[238:239], v[224:225]
    v_pk_mul_f32 v[232:233], v[48:49], v[48:49]
    v_pk_mul_f32 v[234:235], v[50:51], v[50:51]
    v_pk_mul_f32 v[236:237], v[52:53], v[52:53]
    v_pk_mul_f32 v[238:239], v[54:55], v[54:55]
    v_pk_fma_f32 v[232:233], v[232:233], v[222:223], v[220:221]
    v_pk_fma_f32 v[234:235], v[234:235], v[222:223], v[220:221]
    v_pk_fma_f32 v[236:237], v[236:237], v[222:223], v[220:221]
    v_pk_fma_f32 v[238:239], v[238:239], v[222:223], v[220:221]
    v_pk_mul_f32 v[232:233], v[232:233], v[48:49]
    v_pk_mul_f32 v[234:235], v[234:235], v[50:51]
    v_pk_mul_f32 v[236:237], v[236:237], v[52:53]
    v_pk_mul_f32 v[238:239], v[238:239], v[54:55]
    v_exp_f32 v232, v232
    v_exp_f32 v233, v233
    v_exp_f32 v234, v234
    v_exp_f32 v235, v235
    v_exp_f32 v236, v236
    v_exp_f32 v237, v237
    v_exp_f32 v238, v238
    v_exp_f32 v239, v239
    v_pk_mul_f32 v[48:49], v[48:49], v[88:89]
    v_pk_mul_f32 v[50:51], v[50:51], v[90:91]
    v_pk_mul_f32 v[52:53], v[52:53], v[88:89]
    v_pk_mul_f32 v[54:55], v[54:55], v[90:91]
    v_pk_add_f32 v[232:233], v[232:233], 1.0 op_sel_hi:[1,0]
    v_pk_add_f32 v[234:235], v[234:235], 1.0 op_sel_hi:[1,0]
    v_pk_add_f32 v[236:237], v[236:237], 1.0 op_sel_hi:[1,0]
    v_pk_add_f32 v[238:239], v[238:239], 1.0 op_sel_hi:[1,0]
    v_rcp_f32 v232, v232
    v_rcp_f32 v233, v233
    v_rcp_f32 v234, v234
    v_rcp_f32 v235, v235
    v_rcp_f32 v236, v236
    v_rcp_f32 v237, v237
    v_rcp_f32 v238, v238
    v_rcp_f32 v239, v239
    s_nop 0
    v_pk_fma_f32 v[224:225], v[48:49], v[232:233], v[224:225]
    v_pk_fma_f32 v[224:225], v[50:51], v[234:235], v[224:225]
    v_pk_fma_f32 v[226:227], v[52:53], v[236:237], v[226:227]
    v_pk_fma_f32 v[226:227], v[54:55], v[238:239], v[226:227]
    v_pk_mul_f32 v[232:233], v[56:57], v[56:57]
    v_pk_mul_f32 v[234:235], v[58:59], v[58:59]
    v_pk_mul_f32 v[236:237], v[60:61], v[60:61]
    v_pk_mul_f32 v[238:239], v[62:63], v[62:63]
    v_pk_fma_f32 v[232:233], v[232:233], v[222:223], v[220:221]
    v_pk_fma_f32 v[234:235], v[234:235], v[222:223], v[220:221]
    v_pk_fma_f32 v[236:237], v[236:237], v[222:223], v[220:221]
    v_pk_fma_f32 v[238:239], v[238:239], v[222:223], v[220:221]
    v_pk_mul_f32 v[232:233], v[232:233], v[56:57]
    v_pk_mul_f32 v[234:235], v[234:235], v[58:59]
    v_pk_mul_f32 v[236:237], v[236:237], v[60:61]
    v_pk_mul_f32 v[238:239], v[238:239], v[62:63]
    v_exp_f32 v232, v232
    v_exp_f32 v233, v233
    v_exp_f32 v234, v234
    v_exp_f32 v235, v235
    v_exp_f32 v236, v236
    v_exp_f32 v237, v237
    v_exp_f32 v238, v238
    v_exp_f32 v239, v239
    v_pk_mul_f32 v[56:57], v[56:57], v[88:89]
    v_pk_mul_f32 v[58:59], v[58:59], v[90:91]
    v_pk_mul_f32 v[60:61], v[60:61], v[88:89]
    v_pk_mul_f32 v[62:63], v[62:63], v[90:91]
    v_pk_add_f32 v[232:233], v[232:233], 1.0 op_sel_hi:[1,0]
    v_pk_add_f32 v[234:235], v[234:235], 1.0 op_sel_hi:[1,0]
    v_pk_add_f32 v[236:237], v[236:237], 1.0 op_sel_hi:[1,0]
    v_pk_add_f32 v[238:239], v[238:239], 1.0 op_sel_hi:[1,0]
    v_rcp_f32 v232, v232
    v_rcp_f32 v233, v233
    v_rcp_f32 v234, v234
    v_rcp_f32 v235, v235
    v_rcp_f32 v236, v236
    v_rcp_f32 v237, v237
    v_rcp_f32 v238, v238
    v_rcp_f32 v239, v239
    s_nop 0
    v_pk_fma_f32 v[228:229], v[56:57], v[232:233], v[228:229]
    v_pk_fma_f32 v[228:229], v[58:59], v[234:235], v[228:229]
    v_pk_fma_f32 v[230:231], v[60:61], v[236:237], v[230:231]
    v_pk_fma_f32 v[230:231], v[62:63], v[238:239], v[230:231]
    v_pk_mul_f32 v[232:233], v[76:77], v[76:77]
    v_pk_mul_f32 v[234:235], v[78:79], v[78:79]
    v_pk_mul_f32 v[236:237], v[72:73], v[72:73]
    v_pk_mul_f32 v[238:239], v[74:75], v[74:75]
    v_pk_fma_f32 v[232:233], v[232:233], v[222:223], v[220:221]
    v_pk_fma_f32 v[234:235], v[234:235], v[222:223], v[220:221]
    v_pk_fma_f32 v[236:237], v[236:237], v[222:223], v[220:221]
    v_pk_fma_f32 v[238:239], v[238:239], v[222:223], v[220:221]
    v_pk_mul_f32 v[232:233], v[232:233], v[76:77]
    v_pk_mul_f32 v[234:235], v[234:235], v[78:79]
    v_pk_mul_f32 v[236:237], v[236:237], v[72:73]
    v_pk_mul_f32 v[238:239], v[238:239], v[74:75]
    v_exp_f32 v232, v232
    v_exp_f32 v233, v233
    v_exp_f32 v234, v234
    v_exp_f32 v235, v235
    v_exp_f32 v236, v236
    v_exp_f32 v237, v237
    v_exp_f32 v238, v238
    v_exp_f32 v239, v239
    v_pk_mul_f32 v[76:77], v[76:77], v[92:93]
    v_pk_mul_f32 v[78:79], v[78:79], v[94:95]
    v_pk_mul_f32 v[72:73], v[72:73], v[92:93]
    v_pk_mul_f32 v[74:75], v[74:75], v[94:95]
    v_pk_add_f32 v[232:233], v[232:233], 1.0 op_sel_hi:[1,0]
    v_pk_add_f32 v[234:235], v[234:235], 1.0 op_sel_hi:[1,0]
    v_pk_add_f32 v[236:237], v[236:237], 1.0 op_sel_hi:[1,0]
    v_pk_add_f32 v[238:239], v[238:239], 1.0 op_sel_hi:[1,0]
    v_rcp_f32 v232, v232
    v_rcp_f32 v233, v233
    v_rcp_f32 v234, v234
    v_rcp_f32 v235, v235
    v_rcp_f32 v236, v236
    v_rcp_f32 v237, v237
    v_rcp_f32 v238, v238
    v_rcp_f32 v239, v239
    s_nop 0
    v_pk_fma_f32 v[230:231], v[76:77], v[232:233], v[230:231]
    v_pk_fma_f32 v[230:231], v[78:79], v[234:235], v[230:231]
    v_pk_fma_f32 v[228:229], v[72:73], v[236:237], v[228:229]
    v_pk_fma_f32 v[228:229], v[74:75], v[238:239], v[228:229]
    v_pk_mul_f32 v[232:233], v[68:69], v[68:69]
    v_pk_mul_f32 v[234:235], v[70:71], v[70:71]
    v_pk_mul_f32 v[236:237], v[64:65], v[64:65]
    v_pk_mul_f32 v[238:239], v[66:67], v[66:67]
    v_pk_fma_f32 v[232:233], v[232:233], v[222:223], v[220:221]
    v_pk_fma_f32 v[234:235], v[234:235], v[222:223], v[220:221]
    v_pk_fma_f32 v[236:237], v[236:237], v[222:223], v[220:221]
    v_pk_fma_f32 v[238:239], v[238:239], v[222:223], v[220:221]
    v_pk_mul_f32 v[232:233], v[232:233], v[68:69]
    v_pk_mul_f32 v[234:235], v[234:235], v[70:71]
    v_pk_mul_f32 v[236:237], v[236:237], v[64:65]
    v_pk_mul_f32 v[238:239], v[238:239], v[66:67]
    v_exp_f32 v232, v232
    v_exp_f32 v233, v233
    v_exp_f32 v234, v234
    v_exp_f32 v235, v235
    v_exp_f32 v236, v236
    v_exp_f32 v237, v237
    v_exp_f32 v238, v238
    v_exp_f32 v239, v239
    v_pk_mul_f32 v[68:69], v[68:69], v[92:93]
    v_pk_mul_f32 v[70:71], v[70:71], v[94:95]
    v_pk_mul_f32 v[64:65], v[64:65], v[92:93]
    v_pk_mul_f32 v[66:67], v[66:67], v[94:95]
    v_pk_add_f32 v[232:233], v[232:233], 1.0 op_sel_hi:[1,0]
    v_pk_add_f32 v[234:235], v[234:235], 1.0 op_sel_hi:[1,0]
    v_pk_add_f32 v[236:237], v[236:237], 1.0 op_sel_hi:[1,0]
    v_pk_add_f32 v[238:239], v[238:239], 1.0 op_sel_hi:[1,0]
    v_rcp_f32 v232, v232
    v_rcp_f32 v233, v233
    v_rcp_f32 v234, v234
    v_rcp_f32 v235, v235
    v_rcp_f32 v236, v236
    v_rcp_f32 v237, v237
    v_rcp_f32 v238, v238
    v_rcp_f32 v239, v239
    s_nop 0
    v_pk_fma_f32 v[226:227], v[68:69], v[232:233], v[226:227]
    v_pk_fma_f32 v[226:227], v[70:71], v[234:235], v[226:227]
    v_pk_fma_f32 v[224:225], v[64:65], v[236:237], v[224:225]
    v_pk_fma_f32 v[224:225], v[66:67], v[238:239], v[224:225]
    v_add_f32 v224, v224, v225
    v_add_f32 v226, v226, v227
    v_add_f32 v228, v228, v229
    v_add_f32 v230, v230, v231
    s_nop 1
    v_permlane32_swap_b32 v224, v228
    v_permlane32_swap_b32 v226, v230
    s_nop 1
    v_add_f32 v224, v224, v228
    v_add_f32 v226, v226, v230
    s_nop 1
    v_permlane16_swap_b32 v224, v226
    s_nop 1
    v_add_f32 v224, v224, v226
    buffer_store_dword v224, v1, s[48:51], s68 offen sc1
    s_waitcnt vmcnt(0)
    s_branch L_join
L_loader:
    s_setprio 2
    s_sub_u32 s99, s60, 4
    s_lshl_b32 s67, s99, 5
    s_add_u32 s67, s67, s63
    s_mul_i32 s65, s67, 104
    v_lshrrev_b32 v11, 3, v0
    v_mul_u32_u24 v1, 104, v11
    s_add_u32 s70, s62, s61
    s_lshl1_add_u32 s100, s62, s61
    s_add_u32 s26, s70, 0
    s_and_b32 s26, s26, 3
    s_add_u32 s26, s26, 0
    s_lshl2_add_u32 s69, s26, s65
    buffer_load_dword v16, v1, s[28:31], s69 offen offset:0
    buffer_load_dword v17, v1, s[28:31], s69 offen offset:832
    buffer_load_dword v18, v1, s[28:31], s69 offen offset:1664
    buffer_load_dword v19, v1, s[28:31], s69 offen offset:2496
    v_lshrrev_b32 v2, 4, v0
    v_and_b32 v3, 15, v0
    v_lshlrev_b32 v4, 1, v2
    v_xor_b32 v3, v3, v4
    v_mul_u32_u24 v4, 6656, v2
    v_lshl_add_u32 v8, v3, 4, v4
    v_xor_b32 v3, 8, v3
    v_lshl_add_u32 v9, v3, 4, v4
    s_mul_i32 s98, s99, 106496
    s_lshl_b32 s67, s64, 1
    s_add_u32 s98, s98, s67
    s_lshl_b32 s96, s99, 12
    s_add_u32 s97, s96, 16384
    v_lshlrev_b32 v6, 4, v0
    s_add_u32 m0, s96, 98304
    s_add_u32 s67, s96, 98304
    buffer_load_dwordx4 v6, s[28:31], s65 offen offset:0 lds
    buffer_load_dwordx4 v6, s[28:31], s65 offen offset:1024 lds
    buffer_load_dwordx4 v6, s[28:31], s65 offen offset:2048 lds
    buffer_load_dwordx4 v6, s[28:31], s65 offen offset:3072 lds
    v_add_u32 v10, s67, v1
    s_lshr_b32 s67, s61, 2
    s_mul_i32 s4, s67, 425984
    s_sub_u32 s5, 425984, s4
    s_sub_u32 s5, s5, s4
    s_add_u32 s98, s98, s4
    s_lshl_b32 s6, s67, 7
    s_xor_b32 s7, s6, 128
    v_and_b32 v3, 7, v0
    v_xor_b32 v4, v3, v2
    v_lshlrev_b32 v4, 4, v4
    v_xor_b32 v5, 64, v4
    s_mov_b32 s40, s10
    s_and_b32 s41, s11, 0xffff
    s_mov_b32 s42, 52
    s_mov_b32 s43, 0x20000
    s_lshr_b32 s68, s99, 1
    s_lshl1_add_u32 s68, s62, s68
    s_add_u32 s68, s68, s63
    s_mul_i32 s69, s68, 104
    v_lshlrev_b32 v12, 2, v11
    buffer_load_dword v214, v12, s[28:31], s69 offen offset:0
    buffer_load_dword v215, v12, s[28:31], s69 offen offset:32
    buffer_load_dword v216, v12, s[28:31], s69 offen offset:64
    v_add_u32 v13, 24, v11
    v_subrev_u32 v14, 26, v13
    v_min_u32 v13, v13, v14
    v_lshlrev_b32 v13, 2, v13
    buffer_load_dword v217, v13, s[28:31], s69 offen
    s_add_u32 s27, s70, 0
    s_and_b32 s27, s27, 3
    s_add_u32 s27, s27, 0
    s_mul_i32 s71, s27, 851968
    s_add_u32 s71, s71, s98
    s_add_u32 m0, s97, 0
    s_add_u32 s67, s71, 0
    buffer_load_dwordx4 v8, s[36:39], s67 offen  lds
    s_add_u32 m0, s97, 1024
    s_add_u32 s67, s71, 26624
    buffer_load_dwordx4 v8, s[36:39], s67 offen  lds
    s_add_u32 m0, s97, 2048
    s_add_u32 s67, s71, 53248
    buffer_load_dwordx4 v9, s[36:39], s67 offen  lds
    s_add_u32 m0, s97, 3072
    s_add_u32 s67, s71, 79872
    buffer_load_dwordx4 v9, s[36:39], s67 offen  lds
    v_lshrrev_b32 v13, 5, v0
    v_lshlrev_b32 v12, 3, v13
    buffer_load_dwordx2 v[100:101], v12, s[40:43], 0 offen offset:0
    buffer_load_dwordx2 v[102:103], v12, s[40:43], 0 offen offset:16
    buffer_load_dwordx2 v[104:105], v12, s[40:43], 0 offen offset:32
    buffer_load_dwordx2 v[106:107], v12, s[40:43], 0 offen offset:48
    v_and_b32 v12, 31, v0
    v_lshlrev_b32 v12, 1, v12
    v_lshl_add_u32 v12, v13, 7, v12
    s_add_u32 s69, s96, 114688
    v_add_u32 v218, s69, v12
    v_and_b32 v12, 31, v0
    v_mul_u32_u24 v219, 784, v12
    v_lshlrev_b32 v12, 4, v12
    v_add_u32 v12, 19968, v12
    v_min_u32 v219, v219, v12
    v_lshrrev_b32 v13, 5, v0
    v_lshl_add_u32 v219, v13, 4, v219
    v_add_u32 v219, 114688, v219
    v_mov_b32 v32, 0
    v_mov_b32 v33, 0
    v_mov_b32 v34, 0
    v_mov_b32 v35, 0
    v_mov_b32 v36, 0
    v_mov_b32 v37, 0
    v_mov_b32 v38, 0
    v_mov_b32 v39, 0
    v_mov_b32 v40, 0
    v_mov_b32 v41, 0
    v_mov_b32 v42, 0
    v_mov_b32 v43, 0
    v_mov_b32 v44, 0
    v_mov_b32 v45, 0
    v_mov_b32 v46, 0
    v_mov_b32 v47, 0
    v_mov_b32 v48, 0
    v_mov_b32 v49, 0
    v_mov_b32 v50, 0
    v_mov_b32 v51, 0
    v_mov_b32 v52, 0
    v_mov_b32 v53, 0
    v_mov_b32 v54, 0
    v_mov_b32 v55, 0
    v_mov_b32 v56, 0
    v_mov_b32 v57, 0
    v_mov_b32 v58, 0
    v_mov_b32 v59, 0
    v_mov_b32 v60, 0
    v_mov_b32 v61, 0
    v_mov_b32 v62, 0
    v_mov_b32 v63, 0
    v_mov_b32 v64, 0
    v_mov_b32 v65, 0
    v_mov_b32 v66, 0
    v_mov_b32 v67, 0
    v_mov_b32 v68, 0
    v_mov_b32 v69, 0
    v_mov_b32 v70, 0
    v_mov_b32 v71, 0
    v_mov_b32 v72, 0
    v_mov_b32 v73, 0
    v_mov_b32 v74, 0
    v_mov_b32 v75, 0
    v_mov_b32 v76, 0
    v_mov_b32 v77, 0
    v_mov_b32 v78, 0
    v_mov_b32 v79, 0
    v_mov_b32 v80, 0
    v_mov_b32 v81, 0
    v_mov_b32 v82, 0
    v_mov_b32 v83, 0
    v_mov_b32 v116, 0
    v_mov_b32 v117, 0
    v_mov_b32 v118, 0
    v_mov_b32 v119, 0
    v_lshlrev_b32 v12, 4, v0
    v_add_u32 v12, 135072, v12
    s_mov_b32 exec_hi, 0x1fffff
    ds_write_b128 v12, v[116:119]
    ds_write_b128 v12, v[116:119] offset:21232
    s_mov_b64 exec, -1
    v_mov_b32 v220, 0
    s_waitcnt vmcnt(8)
    v_lshl_add_u32 v16, v16, 8, v4
    v_lshl_add_u32 v17, v17, 8, v5
    v_lshl_add_u32 v18, v18, 8, v4
    v_lshl_add_u32 v19, v19, 8, v5
    s_mov_b32 s67, s6
    s_add_u32 m0, s96, 0
    s_nop 0
    buffer_load_dwordx4 v16, s[32:35], s67 offen  lds
    s_add_u32 m0, s96, 1024
    s_nop 0
    buffer_load_dwordx4 v17, s[32:35], s67 offen  lds
    s_add_u32 m0, s96, 2048
    s_nop 0
    buffer_load_dwordx4 v18, s[32:35], s67 offen  lds
    s_add_u32 m0, s96, 3072
    s_nop 0
    buffer_load_dwordx4 v19, s[32:35], s67 offen  lds
    s_add_u32 s26, s70, 1
    s_and_b32 s26, s26, 3
    s_add_u32 s26, s26, 0
    s_lshl_b32 s26, s26, 2
    v_add_u32 v7, s26, v10
    ds_read_b32 v20, v7 offset:0
    ds_read_b32 v21, v7 offset:832
    ds_read_b32 v22, v7 offset:1664
    ds_read_b32 v23, v7 offset:2496
    s_add_u32 s71, s71, s5
    s_add_u32 m0, s97, 32768
    s_add_u32 s67, s71, 0
    buffer_load_dwordx4 v8, s[36:39], s67 offen  lds
    s_add_u32 m0, s97, 33792
    s_add_u32 s67, s71, 26624
    buffer_load_dwordx4 v8, s[36:39], s67 offen  lds
    s_add_u32 m0, s97, 34816
    s_add_u32 s67, s71, 53248
    buffer_load_dwordx4 v9, s[36:39], s67 offen  lds
    s_add_u32 m0, s97, 35840
    s_add_u32 s67, s71, 79872
    buffer_load_dwordx4 v9, s[36:39], s67 offen  lds
    s_mov_b32 s67, s7
    s_add_u32 m0, s96, 32768
    s_nop 0
    buffer_load_dwordx4 v16, s[32:35], s67 offen  lds
    s_add_u32 m0, s96, 33792
    s_nop 0
    buffer_load_dwordx4 v17, s[32:35], s67 offen  lds
    s_add_u32 m0, s96, 34816
    s_nop 0
    buffer_load_dwordx4 v18, s[32:35], s67 offen  lds
    s_add_u32 m0, s96, 35840
    s_nop 0
    buffer_load_dwordx4 v19, s[32:35], s67 offen  lds
    v_lshlrev_b32 v12, 4, v3
    s_and_b32 s69, s99, 1
    s_lshl_b32 s69, s69, 7
    v_lshl_add_u32 v214, v214, 8, v12
    s_add_u32 m0, s96, 114688
    s_nop 0
    buffer_load_dwordx4 v214, s[32:35], s69 offen lds
    v_lshl_add_u32 v215, v215, 8, v12
    s_add_u32 m0, s96, 115712
    s_nop 0
    buffer_load_dwordx4 v215, s[32:35], s69 offen lds
    v_lshl_add_u32 v216, v216, 8, v12
    s_add_u32 m0, s96, 116736
    s_nop 0
    buffer_load_dwordx4 v216, s[32:35], s69 offen lds
    v_lshl_add_u32 v217, v217, 8, v12
    s_add_u32 m0, s96, 117760
    s_nop 0
    buffer_load_dwordx4 v217, s[32:35], s69 offen lds
    v_mov_b32 v12, 0
    s_waitcnt vmcnt(12)
    s_barrier
    s_add_u32 s27, s70, 1
    s_and_b32 s27, s27, 3
    s_add_u32 s27, s27, 0
    s_mul_i32 s71, s27, 851968
    s_add_u32 s71, s71, s98
    s_add_u32 m0, s97, 65536
    s_add_u32 s67, s71, 0
    buffer_load_dwordx4 v8, s[36:39], s67 offen  lds
    s_add_u32 m0, s97, 66560
    s_add_u32 s67, s71, 26624
    buffer_load_dwordx4 v8, s[36:39], s67 offen  lds
    s_add_u32 m0, s97, 67584
    s_add_u32 s67, s71, 53248
    buffer_load_dwordx4 v9, s[36:39], s67 offen  lds
    s_add_u32 m0, s97, 68608
    s_add_u32 s67, s71, 79872
    buffer_load_dwordx4 v9, s[36:39], s67 offen  lds
    s_waitcnt lgkmcnt(0)
    v_lshl_add_u32 v20, v20, 8, v4
    v_lshl_add_u32 v21, v21, 8, v5
    v_lshl_add_u32 v22, v22, 8, v4
    v_lshl_add_u32 v23, v23, 8, v5
    s_mov_b32 s67, s6
    s_add_u32 m0, s96, 65536
    s_nop 0
    buffer_load_dwordx4 v20, s[32:35], s67 offen  lds
    s_add_u32 m0, s96, 66560
    s_nop 0
    buffer_load_dwordx4 v21, s[32:35], s67 offen  lds
    s_add_u32 m0, s96, 67584
    s_nop 0
    buffer_load_dwordx4 v22, s[32:35], s67 offen  lds
    s_add_u32 m0, s96, 68608
    s_nop 0
    buffer_load_dwordx4 v23, s[32:35], s67 offen  lds
    s_add_u32 s26, s70, 2
    s_and_b32 s26, s26, 3
    s_add_u32 s26, s26, 0
    s_lshl_b32 s26, s26, 2
    v_add_u32 v7, s26, v10
    ds_read_b32 v24, v7 offset:0
    ds_read_b32 v25, v7 offset:832
    ds_read_b32 v26, v7 offset:1664
    ds_read_b32 v27, v7 offset:2496
    s_waitcnt vmcnt(12)
    s_barrier
    s_add_u32 s71, s71, s5
    s_add_u32 m0, s97, 0
    s_add_u32 s67, s71, 0
    buffer_load_dwordx4 v8, s[36:39], s67 offen  lds
    s_add_u32 m0, s97, 1024
    s_add_u32 s67, s71, 26624
    buffer_load_dwordx4 v8, s[36:39], s67 offen  lds
    s_add_u32 m0, s97, 2048
    s_add_u32 s67, s71, 53248
    buffer_load_dwordx4 v9, s[36:39], s67 offen  lds
    s_add_u32 m0, s97, 3072
    s_add_u32 s67, s71, 79872
    buffer_load_dwordx4 v9, s[36:39], s67 offen  lds
    s_mov_b32 s67, s7
    s_add_u32 m0, s96, 0
    s_nop 0
    buffer_load_dwordx4 v20, s[32:35], s67 offen  lds
    s_add_u32 m0, s96, 1024
    s_nop 0
    buffer_load_dwordx4 v21, s[32:35], s67 offen  lds
    s_add_u32 m0, s96, 2048
    s_nop 0
    buffer_load_dwordx4 v22, s[32:35], s67 offen  lds
    s_add_u32 m0, s96, 3072
    s_nop 0
    buffer_load_dwordx4 v23, s[32:35], s67 offen  lds
    v_lshlrev_b32 v196, 16, v100
    v_and_b32 v197, 0xffff0000, v100
    v_lshlrev_b32 v198, 16, v101
    v_and_b32 v199, 0xffff0000, v101
    v_lshlrev_b32 v200, 16, v102
    v_and_b32 v201, 0xffff0000, v102
    v_lshlrev_b32 v202, 16, v103
    v_and_b32 v203, 0xffff0000, v103
    v_lshlrev_b32 v204, 16, v104
    v_and_b32 v205, 0xffff0000, v104
    v_lshlrev_b32 v206, 16, v105
    v_and_b32 v207, 0xffff0000, v105
    v_lshlrev_b32 v208, 16, v106
    v_and_b32 v209, 0xffff0000, v106
    v_lshlrev_b32 v210, 16, v107
    v_and_b32 v211, 0xffff0000, v107
    s_waitcnt vmcnt(8)
    s_barrier
    s_add_u32 s27, s70, 2
    s_and_b32 s27, s27, 3
    s_add_u32 s27, s27, 0
    s_mul_i32 s71, s27, 851968
    s_add_u32 s71, s71, s98
    s_add_u32 m0, s97, 32768
    s_add_u32 s67, s71, 0
    buffer_load_dwordx4 v8, s[36:39], s67 offen  lds
    s_add_u32 m0, s97, 33792
    s_add_u32 s67, s71, 26624
    buffer_load_dwordx4 v8, s[36:39], s67 offen  lds
    s_add_u32 m0, s97, 34816
    s_add_u32 s67, s71, 53248
    buffer_load_dwordx4 v9, s[36:39], s67 offen  lds
    s_add_u32 m0, s97, 35840
    s_add_u32 s67, s71, 79872
    buffer_load_dwordx4 v9, s[36:39], s67 offen  lds
    s_waitcnt lgkmcnt(0)
    v_lshl_add_u32 v24, v24, 8, v4
    v_lshl_add_u32 v25, v25, 8, v5
    v_lshl_add_u32 v26, v26, 8, v4
    v_lshl_add_u32 v27, v27, 8, v5
    s_mov_b32 s67, s6
    s_add_u32 m0, s96, 32768
    s_nop 0
    buffer_load_dwordx4 v24, s[32:35], s67 offen  lds
    s_add_u32 m0, s96, 33792
    s_nop 0
    buffer_load_dwordx4 v25, s[32:35], s67 offen  lds
    s_add_u32 m0, s96, 34816
    s_nop 0
    buffer_load_dwordx4 v26, s[32:35], s67 offen  lds
    s_add_u32 m0, s96, 35840
    s_nop 0
    buffer_load_dwordx4 v27, s[32:35], s67 offen  lds
    s_add_u32 s26, s70, 3
    s_and_b32 s26, s26, 3
    s_add_u32 s26, s26, 0
    s_lshl_b32 s26, s26, 2
    v_add_u32 v7, s26, v10
    ds_read_b32 v28, v7 offset:0
    ds_read_b32 v29, v7 offset:832
    ds_read_b32 v30, v7 offset:1664
    ds_read_b32 v31, v7 offset:2496
    ds_read_u16_d16_hi v32, v218 offset:0
    ds_read_u16_d16_hi v33, v218 offset:128
    ds_read_u16_d16_hi v34, v218 offset:256
    ds_read_u16_d16_hi v35, v218 offset:384
    ds_read_u16_d16_hi v36, v218 offset:512
    ds_read_u16_d16_hi v37, v218 offset:640
    ds_read_u16_d16_hi v38, v218 offset:768
    ds_read_u16_d16_hi v39, v218 offset:896
    ds_read_u16_d16_hi v40, v218 offset:1024
    ds_read_u16_d16_hi v41, v218 offset:1152
    ds_read_u16_d16_hi v42, v218 offset:1280
    ds_read_u16_d16_hi v43, v218 offset:1408
    ds_read_u16_d16_hi v44, v218 offset:1536
    ds_read_u16_d16_hi v45, v218 offset:1664
    ds_read_u16_d16_hi v46, v218 offset:1792
    ds_read_u16_d16_hi v47, v218 offset:1920
    ds_read_u16_d16_hi v48, v218 offset:2048
    ds_read_u16_d16_hi v49, v218 offset:2176
    ds_read_u16_d16_hi v50, v218 offset:2304
    ds_read_u16_d16_hi v51, v218 offset:2432
    ds_read_u16_d16_hi v52, v218 offset:2560
    ds_read_u16_d16_hi v53, v218 offset:2688
    ds_read_u16_d16_hi v54, v218 offset:2816
    ds_read_u16_d16_hi v55, v218 offset:2944
    ds_read_u16_d16_hi v56, v218 offset:3072
    ds_read_u16_d16_hi v57, v218 offset:3200
    s_waitcnt vmcnt(8)
    s_barrier
    s_add_u32 s71, s71, s5
    s_add_u32 m0, s97, 65536
    s_add_u32 s67, s71, 0
    buffer_load_dwordx4 v8, s[36:39], s67 offen  lds
    s_add_u32 m0, s97, 66560
    s_add_u32 s67, s71, 26624
    buffer_load_dwordx4 v8, s[36:39], s67 offen  lds
    s_add_u32 m0, s97, 67584
    s_add_u32 s67, s71, 53248
    buffer_load_dwordx4 v9, s[36:39], s67 offen  lds
    s_add_u32 m0, s97, 68608
    s_add_u32 s67, s71, 79872
    buffer_load_dwordx4 v9, s[36:39], s67 offen  lds
    s_mov_b32 s67, s7
    s_add_u32 m0, s96, 65536
    s_nop 0
    buffer_load_dwordx4 v24, s[32:35], s67 offen  lds
    s_add_u32 m0, s96, 66560
    s_nop 0
    buffer_load_dwordx4 v25, s[32:35], s67 offen  lds
    s_add_u32 m0, s96, 67584
    s_nop 0
    buffer_load_dwordx4 v26, s[32:35], s67 offen  lds
    s_add_u32 m0, s96, 68608
    s_nop 0
    buffer_load_dwordx4 v27, s[32:35], s67 offen  lds
    ds_read_u16_d16_hi v58, v218 offset:64
    ds_read_u16_d16_hi v59, v218 offset:192
    ds_read_u16_d16_hi v60, v218 offset:320
    ds_read_u16_d16_hi v61, v218 offset:448
    ds_read_u16_d16_hi v62, v218 offset:576
    ds_read_u16_d16_hi v63, v218 offset:704
    ds_read_u16_d16_hi v64, v218 offset:832
    ds_read_u16_d16_hi v65, v218 offset:960
    ds_read_u16_d16_hi v66, v218 offset:1088
    ds_read_u16_d16_hi v67, v218 offset:1216
    ds_read_u16_d16_hi v68, v218 offset:1344
    ds_read_u16_d16_hi v69, v218 offset:1472
    ds_read_u16_d16_hi v70, v218 offset:1600
    ds_read_u16_d16_hi v71, v218 offset:1728
    ds_read_u16_d16_hi v72, v218 offset:1856
    ds_read_u16_d16_hi v73, v218 offset:1984
    ds_read_u16_d16_hi v74, v218 offset:2112
    ds_read_u16_d16_hi v75, v218 offset:2240
    ds_read_u16_d16_hi v76, v218 offset:2368
    ds_read_u16_d16_hi v77, v218 offset:2496
    ds_read_u16_d16_hi v78, v218 offset:2624
    ds_read_u16_d16_hi v79, v218 offset:2752
    ds_read_u16_d16_hi v80, v218 offset:2880
    ds_read_u16_d16_hi v81, v218 offset:3008
    ds_read_u16_d16_hi v82, v218 offset:3136
    ds_read_u16_d16_hi v83, v218 offset:3264
    s_waitcnt vmcnt(8)
    s_barrier
    s_add_u32 s27, s70, 3
    s_and_b32 s27, s27, 3
    s_add_u32 s27, s27, 0
    s_mul_i32 s71, s27, 851968
    s_add_u32 s71, s71, s98
    s_add_u32 m0, s97, 0
    s_add_u32 s67, s71, 0
    buffer_load_dwordx4 v8, s[36:39], s67 offen  lds
    s_add_u32 m0, s97, 1024
    s_add_u32 s67, s71, 26624
    buffer_load_dwordx4 v8, s[36:39], s67 offen  lds
    s_add_u32 m0, s97, 2048
    s_add_u32 s67, s71, 53248
    buffer_load_dwordx4 v9, s[36:39], s67 offen  lds
    s_add_u32 m0, s97, 3072
    s_add_u32 s67, s71, 79872
    buffer_load_dwordx4 v9, s[36:39], s67 offen  lds
    s_waitcnt lgkmcnt(0)
    v_lshl_add_u32 v28, v28, 8, v4
    v_lshl_add_u32 v29, v29, 8, v5
    v_lshl_add_u32 v30, v30, 8, v4
    v_lshl_add_u32 v31, v31, 8, v5
    s_mov_b32 s67, s6
    s_add_u32 m0, s96, 0
    s_nop 0
    buffer_load_dwordx4 v28, s[32:35], s67 offen  lds
    s_add_u32 m0, s96, 1024
    s_nop 0
    buffer_load_dwordx4 v29, s[32:35], s67 offen  lds
    s_add_u32 m0, s96, 2048
    s_nop 0
    buffer_load_dwordx4 v30, s[32:35], s67 offen  lds
    s_add_u32 m0, s96, 3072
    s_nop 0
    buffer_load_dwordx4 v31, s[32:35], s67 offen  lds
    s_add_u32 s26, s70, 1
    s_and_b32 s26, s26, 3
    s_add_u32 s26, s26, 4
    s_lshl_b32 s26, s26, 2
    v_add_u32 v7, s26, v10
    ds_read_b32 v16, v7 offset:0
    ds_read_b32 v17, v7 offset:832
    ds_read_b32 v18, v7 offset:1664
    ds_read_b32 v19, v7 offset:2496
    s_waitcnt vmcnt(8)
    s_barrier
    s_add_u32 s71, s71, s5
    s_add_u32 m0, s97, 32768
    s_add_u32 s67, s71, 0
    buffer_load_dwordx4 v8, s[36:39], s67 offen  lds
    s_add_u32 m0, s97, 33792
    s_add_u32 s67, s71, 26624
    buffer_load_dwordx4 v8, s[36:39], s67 offen  lds
    s_add_u32 m0, s97, 34816
    s_add_u32 s67, s71, 53248
    buffer_load_dwordx4 v9, s[36:39], s67 offen  lds
    s_add_u32 m0, s97, 35840
    s_add_u32 s67, s71, 79872
    buffer_load_dwordx4 v9, s[36:39], s67 offen  lds
    s_mov_b32 s67, s7
    s_add_u32 m0, s96, 32768
    s_nop 0
    buffer_load_dwordx4 v28, s[32:35], s67 offen  lds
    s_add_u32 m0, s96, 33792
    s_nop 0
    buffer_load_dwordx4 v29, s[32:35], s67 offen  lds
    s_add_u32 m0, s96, 34816
    s_nop 0
    buffer_load_dwordx4 v30, s[32:35], s67 offen  lds
    s_add_u32 m0, s96, 35840
    s_nop 0
    buffer_load_dwordx4 v31, s[32:35], s67 offen  lds
    s_waitcnt vmcnt(8)
    s_barrier
    s_add_u32 s27, s70, 1
    s_and_b32 s27, s27, 3
    s_add_u32 s27, s27, 4
    s_mul_i32 s71, s27, 851968
    s_add_u32 s71, s71, s98
    s_add_u32 m0, s97, 65536
    s_add_u32 s67, s71, 0
    buffer_load_dwordx4 v8, s[36:39], s67 offen  lds
    s_add_u32 m0, s97, 66560
    s_add_u32 s67, s71, 26624
    buffer_load_dwordx4 v8, s[36:39], s67 offen  lds
    s_add_u32 m0, s97, 67584
    s_add_u32 s67, s71, 53248
    buffer_load_dwordx4 v9, s[36:39], s67 offen  lds
    s_add_u32 m0, s97, 68608
    s_add_u32 s67, s71, 79872
    buffer_load_dwordx4 v9, s[36:39], s67 offen  lds
    s_waitcnt lgkmcnt(0)
    v_lshl_add_u32 v16, v16, 8, v4
    v_lshl_add_u32 v17, v17, 8, v5
    v_lshl_add_u32 v18, v18, 8, v4
    v_lshl_add_u32 v19, v19, 8, v5
    s_mov_b32 s67, s6
    s_add_u32 m0, s96, 65536
    s_nop 0
    buffer_load_dwordx4 v16, s[32:35], s67 offen  lds
    s_add_u32 m0, s96, 66560
    s_nop 0
    buffer_load_dwordx4 v17, s[32:35], s67 offen  lds
    s_add_u32 m0, s96, 67584
    s_nop 0
    buffer_load_dwordx4 v18, s[32:35], s67 offen  lds
    s_add_u32 m0, s96, 68608
    s_nop 0
    buffer_load_dwordx4 v19, s[32:35], s67 offen  lds
    s_add_u32 s26, s70, 2
    s_and_b32 s26, s26, 3
    s_add_u32 s26, s26, 4
    s_lshl_b32 s26, s26, 2
    v_add_u32 v7, s26, v10
    ds_read_b32 v20, v7 offset:0
    ds_read_b32 v21, v7 offset:832
    ds_read_b32 v22, v7 offset:1664
    ds_read_b32 v23, v7 offset:2496
    s_waitcnt vmcnt(8)
    s_barrier
    s_add_u32 s71, s71, s5
    s_add_u32 m0, s97, 0
    s_add_u32 s67, s71, 0
    buffer_load_dwordx4 v8, s[36:39], s67 offen  lds
    s_add_u32 m0, s97, 1024
    s_add_u32 s67, s71, 26624
    buffer_load_dwordx4 v8, s[36:39], s67 offen  lds
    s_add_u32 m0, s97, 2048
    s_add_u32 s67, s71, 53248
    buffer_load_dwordx4 v9, s[36:39], s67 offen  lds
    s_add_u32 m0, s97, 3072
    s_add_u32 s67, s71, 79872
    buffer_load_dwordx4 v9, s[36:39], s67 offen  lds
    s_mov_b32 s67, s7
    s_add_u32 m0, s96, 0
    s_nop 0
    buffer_load_dwordx4 v16, s[32:35], s67 offen  lds
    s_add_u32 m0, s96, 1024
    s_nop 0
    buffer_load_dwordx4 v17, s[32:35], s67 offen  lds
    s_add_u32 m0, s96, 2048
    s_nop 0
    buffer_load_dwordx4 v18, s[32:35], s67 offen  lds
    s_add_u32 m0, s96, 3072
    s_nop 0
    buffer_load_dwordx4 v19, s[32:35], s67 offen  lds
    s_waitcnt vmcnt(8)
    s_barrier
    s_add_u32 s27, s70, 2
    s_and_b32 s27, s27, 3
    s_add_u32 s27, s27, 4
    s_mul_i32 s71, s27, 851968
    s_add_u32 s71, s71, s98
    s_add_u32 m0, s97, 32768
    s_add_u32 s67, s71, 0
    buffer_load_dwordx4 v8, s[36:39], s67 offen  lds
    s_add_u32 m0, s97, 33792
    s_add_u32 s67, s71, 26624
    buffer_load_dwordx4 v8, s[36:39], s67 offen  lds
    s_add_u32 m0, s97, 34816
    s_add_u32 s67, s71, 53248
    buffer_load_dwordx4 v9, s[36:39], s67 offen  lds
    s_add_u32 m0, s97, 35840
    s_add_u32 s67, s71, 79872
    buffer_load_dwordx4 v9, s[36:39], s67 offen  lds
    s_waitcnt lgkmcnt(0)
    v_lshl_add_u32 v20, v20, 8, v4
    v_lshl_add_u32 v21, v21, 8, v5
    v_lshl_add_u32 v22, v22, 8, v4
    v_lshl_add_u32 v23, v23, 8, v5
    s_mov_b32 s67, s6
    s_add_u32 m0, s96, 32768
    s_nop 0
    buffer_load_dwordx4 v20, s[32:35], s67 offen  lds
    s_add_u32 m0, s96, 33792
    s_nop 0
    buffer_load_dwordx4 v21, s[32:35], s67 offen  lds
    s_add_u32 m0, s96, 34816
    s_nop 0
    buffer_load_dwordx4 v22, s[32:35], s67 offen  lds
    s_add_u32 m0, s96, 35840
    s_nop 0
    buffer_load_dwordx4 v23, s[32:35], s67 offen  lds
    s_add_u32 s26, s70, 3
    s_and_b32 s26, s26, 3
    s_add_u32 s26, s26, 4
    s_lshl_b32 s26, s26, 2
    v_add_u32 v7, s26, v10
    ds_read_b32 v24, v7 offset:0
    ds_read_b32 v25, v7 offset:832
    ds_read_b32 v26, v7 offset:1664
    ds_read_b32 v27, v7 offset:2496
    s_waitcnt vmcnt(8)
    s_barrier
    s_add_u32 s71, s71, s5
    s_add_u32 m0, s97, 65536
    s_add_u32 s67, s71, 0
    buffer_load_dwordx4 v8, s[36:39], s67 offen  lds
    s_add_u32 m0, s97, 66560
    s_add_u32 s67, s71, 26624
    buffer_load_dwordx4 v8, s[36:39], s67 offen  lds
    s_add_u32 m0, s97, 67584
    s_add_u32 s67, s71, 53248
    buffer_load_dwordx4 v9, s[36:39], s67 offen  lds
    s_add_u32 m0, s97, 68608
    s_add_u32 s67, s71, 79872
    buffer_load_dwordx4 v9, s[36:39], s67 offen  lds
    s_mov_b32 s67, s7
    s_add_u32 m0, s96, 65536
    s_nop 0
    buffer_load_dwordx4 v20, s[32:35], s67 offen  lds
    s_add_u32 m0, s96, 66560
    s_nop 0
    buffer_load_dwordx4 v21, s[32:35], s67 offen  lds
    s_add_u32 m0, s96, 67584
    s_nop 0
    buffer_load_dwordx4 v22, s[32:35], s67 offen  lds
    s_add_u32 m0, s96, 68608
    s_nop 0
    buffer_load_dwordx4 v23, s[32:35], s67 offen  lds
    s_waitcnt vmcnt(8)
    s_barrier
    s_mov_b64 exec, 1
    buffer_load_dword v220, v12, s[52:55], 0 offen offset:128 sc1
    s_mov_b64 exec, -1
    s_add_u32 s27, s70, 3
    s_and_b32 s27, s27, 3
    s_add_u32 s27, s27, 4
    s_mul_i32 s71, s27, 851968
    s_add_u32 s71, s71, s98
    s_add_u32 m0, s97, 0
    s_add_u32 s67, s71, 0
    buffer_load_dwordx4 v8, s[36:39], s67 offen  lds
    s_add_u32 m0, s97, 1024
    s_add_u32 s67, s71, 26624
    buffer_load_dwordx4 v8, s[36:39], s67 offen  lds
    s_add_u32 m0, s97, 2048
    s_add_u32 s67, s71, 53248
    buffer_load_dwordx4 v9, s[36:39], s67 offen  lds
    s_add_u32 m0, s97, 3072
    s_add_u32 s67, s71, 79872
    buffer_load_dwordx4 v9, s[36:39], s67 offen  lds
    s_waitcnt lgkmcnt(0)
    v_lshl_add_u32 v24, v24, 8, v4
    v_lshl_add_u32 v25, v25, 8, v5
    v_lshl_add_u32 v26, v26, 8, v4
    v_lshl_add_u32 v27, v27, 8, v5
    s_mov_b32 s67, s6
    s_add_u32 m0, s96, 0
    s_nop 0
    buffer_load_dwordx4 v24, s[32:35], s67 offen  lds
    s_add_u32 m0, s96, 1024
    s_nop 0
    buffer_load_dwordx4 v25, s[32:35], s67 offen  lds
    s_add_u32 m0, s96, 2048
    s_nop 0
    buffer_load_dwordx4 v26, s[32:35], s67 offen  lds
    s_add_u32 m0, s96, 3072
    s_nop 0
    buffer_load_dwordx4 v27, s[32:35], s67 offen  lds
    s_add_u32 s26, s70, 4
    s_and_b32 s26, s26, 3
    s_add_u32 s26, s26, 4
    s_lshl_b32 s26, s26, 2
    v_add_u32 v7, s26, v10
    ds_read_b32 v28, v7 offset:0
    ds_read_b32 v29, v7 offset:832
    ds_read_b32 v30, v7 offset:1664
    ds_read_b32 v31, v7 offset:2496
    s_waitcnt vmcnt(9)
    s_barrier
    s_add_u32 s71, s71, s5
    s_add_u32 m0, s97, 32768
    s_add_u32 s67, s71, 0
    buffer_load_dwordx4 v8, s[36:39], s67 offen  lds
    s_add_u32 m0, s97, 33792
    s_add_u32 s67, s71, 26624
    buffer_load_dwordx4 v8, s[36:39], s67 offen  lds
    s_add_u32 m0, s97, 34816
    s_add_u32 s67, s71, 53248
    buffer_load_dwordx4 v9, s[36:39], s67 offen  lds
    s_add_u32 m0, s97, 35840
    s_add_u32 s67, s71, 79872
    buffer_load_dwordx4 v9, s[36:39], s67 offen  lds
    s_mov_b32 s67, s7
    s_add_u32 m0, s96, 32768
    s_nop 0
    buffer_load_dwordx4 v24, s[32:35], s67 offen  lds
    s_add_u32 m0, s96, 33792
    s_nop 0
    buffer_load_dwordx4 v25, s[32:35], s67 offen  lds
    s_add_u32 m0, s96, 34816
    s_nop 0
    buffer_load_dwordx4 v26, s[32:35], s67 offen  lds
    s_add_u32 m0, s96, 35840
    s_nop 0
    buffer_load_dwordx4 v27, s[32:35], s67 offen  lds
    s_waitcnt vmcnt(8)
    s_barrier
L_pollchk:
    v_readfirstlane_b32 s69, v220
    s_cmp_lg_u32 s69, 0
    s_cbranch_scc1 L_pollok
    s_sleep 8
    s_mov_b64 exec, 1
    buffer_load_dword v220, v12, s[52:55], 0 offen offset:128 sc1
    s_mov_b64 exec, -1
    s_waitcnt vmcnt(0)
    s_branch L_pollchk
L_pollok:
    s_mov_b32 exec_hi, 0xffff
    s_add_u32 s68, s99, 48
    s_mul_i32 s69, s68, 784
    s_cmp_ge_u32 s68, 26
    s_cselect_b32 s67, 848, 0
    s_add_u32 s69, s69, s67
    s_add_u32 m0, s69, 114688
    s_lshl_b32 s68, s68, 10
    s_add_u32 s68, s68, 655360
    buffer_load_dwordx4 v6, s[48:51], s68 offen sc1 lds
    s_add_u32 s68, s99, 44
    s_mul_i32 s69, s68, 784
    s_cmp_ge_u32 s68, 26
    s_cselect_b32 s67, 848, 0
    s_add_u32 s69, s69, s67
    s_add_u32 m0, s69, 114688
    s_lshl_b32 s68, s68, 10
    s_add_u32 s68, s68, 655360
    buffer_load_dwordx4 v6, s[48:51], s68 offen sc1 lds
    s_add_u32 s68, s99, 40
    s_mul_i32 s69, s68, 784
    s_cmp_ge_u32 s68, 26
    s_cselect_b32 s67, 848, 0
    s_add_u32 s69, s69, s67
    s_add_u32 m0, s69, 114688
    s_lshl_b32 s68, s68, 10
    s_add_u32 s68, s68, 655360
    buffer_load_dwordx4 v6, s[48:51], s68 offen sc1 lds
    s_add_u32 s68, s99, 36
    s_mul_i32 s69, s68, 784
    s_cmp_ge_u32 s68, 26
    s_cselect_b32 s67, 848, 0
    s_add_u32 s69, s69, s67
    s_add_u32 m0, s69, 114688
    s_lshl_b32 s68, s68, 10
    s_add_u32 s68, s68, 655360
    buffer_load_dwordx4 v6, s[48:51], s68 offen sc1 lds
    s_mov_b64 exec, -1
    s_add_u32 s27, s70, 4
    s_and_b32 s27, s27, 3
    s_add_u32 s27, s27, 4
    s_mul_i32 s71, s27, 851968
    s_add_u32 s71, s71, s98
    s_add_u32 m0, s97, 65536
    s_add_u32 s67, s71, 0
    buffer_load_dwordx4 v8, s[36:39], s67 offen  lds
    s_add_u32 m0, s97, 66560
    s_add_u32 s67, s71, 26624
    buffer_load_dwordx4 v8, s[36:39], s67 offen  lds
    s_add_u32 m0, s97, 67584
    s_add_u32 s67, s71, 53248
    buffer_load_dwordx4 v9, s[36:39], s67 offen  lds
    s_add_u32 m0, s97, 68608
    s_add_u32 s67, s71, 79872
    buffer_load_dwordx4 v9, s[36:39], s67 offen  lds
    s_waitcnt lgkmcnt(0)
    v_lshl_add_u32 v28, v28, 8, v4
    v_lshl_add_u32 v29, v29, 8, v5
    v_lshl_add_u32 v30, v30, 8, v4
    v_lshl_add_u32 v31, v31, 8, v5
    s_mov_b32 s67, s6
    s_add_u32 m0, s96, 65536
    s_nop 0
    buffer_load_dwordx4 v28, s[32:35], s67 offen  lds
    s_add_u32 m0, s96, 66560
    s_nop 0
    buffer_load_dwordx4 v29, s[32:35], s67 offen  lds
    s_add_u32 m0, s96, 67584
    s_nop 0
    buffer_load_dwordx4 v30, s[32:35], s67 offen  lds
    s_add_u32 m0, s96, 68608
    s_nop 0
    buffer_load_dwordx4 v31, s[32:35], s67 offen  lds
    s_add_u32 s26, s70, 2
    s_and_b32 s26, s26, 3
    s_add_u32 s26, s26, 8
    s_lshl_b32 s26, s26, 2
    v_add_u32 v7, s26, v10
    ds_read_b32 v16, v7 offset:0
    ds_read_b32 v17, v7 offset:832
    ds_read_b32 v18, v7 offset:1664
    ds_read_b32 v19, v7 offset:2496
    s_waitcnt vmcnt(12)
    s_barrier
    s_mov_b32 exec_hi, 0xffff
    s_add_u32 s68, s99, 32
    s_mul_i32 s69, s68, 784
    s_cmp_ge_u32 s68, 26
    s_cselect_b32 s67, 848, 0
    s_add_u32 s69, s69, s67
    s_add_u32 m0, s69, 114688
    s_lshl_b32 s68, s68, 10
    s_add_u32 s68, s68, 655360
    buffer_load_dwordx4 v6, s[48:51], s68 offen sc1 lds
    s_add_u32 s68, s99, 28
    s_mul_i32 s69, s68, 784
    s_cmp_ge_u32 s68, 26
    s_cselect_b32 s67, 848, 0
    s_add_u32 s69, s69, s67
    s_add_u32 m0, s69, 114688
    s_lshl_b32 s68, s68, 10
    s_add_u32 s68, s68, 655360
    buffer_load_dwordx4 v6, s[48:51], s68 offen sc1 lds
    s_add_u32 s68, s99, 24
    s_mul_i32 s69, s68, 784
    s_cmp_ge_u32 s68, 26
    s_cselect_b32 s67, 848, 0
    s_add_u32 s69, s69, s67
    s_add_u32 m0, s69, 114688
    s_lshl_b32 s68, s68, 10
    s_add_u32 s68, s68, 655360
    buffer_load_dwordx4 v6, s[48:51], s68 offen sc1 lds
    s_mov_b64 exec, -1
    s_add_u32 s71, s71, s5
    s_add_u32 m0, s97, 0
    s_add_u32 s67, s71, 0
    buffer_load_dwordx4 v8, s[36:39], s67 offen  lds
    s_add_u32 m0, s97, 1024
    s_add_u32 s67, s71, 26624
    buffer_load_dwordx4 v8, s[36:39], s67 offen  lds
    s_add_u32 m0, s97, 2048
    s_add_u32 s67, s71, 53248
    buffer_load_dwordx4 v9, s[36:39], s67 offen  lds
    s_add_u32 m0, s97, 3072
    s_add_u32 s67, s71, 79872
    buffer_load_dwordx4 v9, s[36:39], s67 offen  lds
    s_mov_b32 s67, s7
    s_add_u32 m0, s96, 0
    s_nop 0
    buffer_load_dwordx4 v28, s[32:35], s67 offen  lds
    s_add_u32 m0, s96, 1024
    s_nop 0
    buffer_load_dwordx4 v29, s[32:35], s67 offen  lds
    s_add_u32 m0, s96, 2048
    s_nop 0
    buffer_load_dwordx4 v30, s[32:35], s67 offen  lds
    s_add_u32 m0, s96, 3072
    s_nop 0
    buffer_load_dwordx4 v31, s[32:35], s67 offen  lds
    s_waitcnt vmcnt(11)
    s_barrier
    s_mov_b32 exec_hi, 0xffff
    s_add_u32 s68, s99, 20
    s_mul_i32 s69, s68, 784
    s_cmp_ge_u32 s68, 26
    s_cselect_b32 s67, 848, 0
    s_add_u32 s69, s69, s67
    s_add_u32 m0, s69, 114688
    s_lshl_b32 s68, s68, 10
    s_add_u32 s68, s68, 655360
    buffer_load_dwordx4 v6, s[48:51], s68 offen sc1 lds
    s_add_u32 s68, s99, 16
    s_mul_i32 s69, s68, 784
    s_cmp_ge_u32 s68, 26
    s_cselect_b32 s67, 848, 0
    s_add_u32 s69, s69, s67
    s_add_u32 m0, s69, 114688
    s_lshl_b32 s68, s68, 10
    s_add_u32 s68, s68, 655360
    buffer_load_dwordx4 v6, s[48:51], s68 offen sc1 lds
    s_add_u32 s68, s99, 12
    s_mul_i32 s69, s68, 784
    s_cmp_ge_u32 s68, 26
    s_cselect_b32 s67, 848, 0
    s_add_u32 s69, s69, s67
    s_add_u32 m0, s69, 114688
    s_lshl_b32 s68, s68, 10
    s_add_u32 s68, s68, 655360
    buffer_load_dwordx4 v6, s[48:51], s68 offen sc1 lds
    s_mov_b64 exec, -1
    s_add_u32 s27, s70, 2
    s_and_b32 s27, s27, 3
    s_add_u32 s27, s27, 8
    s_mul_i32 s71, s27, 851968
    s_add_u32 s71, s71, s98
    s_add_u32 m0, s97, 32768
    s_add_u32 s67, s71, 0
    buffer_load_dwordx4 v8, s[36:39], s67 offen  lds
    s_add_u32 m0, s97, 33792
    s_add_u32 s67, s71, 26624
    buffer_load_dwordx4 v8, s[36:39], s67 offen  lds
    s_add_u32 m0, s97, 34816
    s_add_u32 s67, s71, 53248
    buffer_load_dwordx4 v9, s[36:39], s67 offen  lds
    s_add_u32 m0, s97, 35840
    s_add_u32 s67, s71, 79872
    buffer_load_dwordx4 v9, s[36:39], s67 offen  lds
    s_waitcnt lgkmcnt(0)
    v_lshl_add_u32 v16, v16, 8, v4
    v_lshl_add_u32 v17, v17, 8, v5
    v_lshl_add_u32 v18, v18, 8, v4
    v_lshl_add_u32 v19, v19, 8, v5
    s_mov_b32 s67, s6
    s_add_u32 m0, s96, 32768
    s_nop 0
    buffer_load_dwordx4 v16, s[32:35], s67 offen  lds
    s_add_u32 m0, s96, 33792
    s_nop 0
    buffer_load_dwordx4 v17, s[32:35], s67 offen  lds
    s_add_u32 m0, s96, 34816
    s_nop 0
    buffer_load_dwordx4 v18, s[32:35], s67 offen  lds
    s_add_u32 m0, s96, 35840
    s_nop 0
    buffer_load_dwordx4 v19, s[32:35], s67 offen  lds
    s_add_u32 s26, s70, 3
    s_and_b32 s26, s26, 3
    s_add_u32 s26, s26, 8
    s_lshl_b32 s26, s26, 2
    v_add_u32 v7, s26, v10
    ds_read_b32 v20, v7 offset:0
    ds_read_b32 v21, v7 offset:832
    ds_read_b32 v22, v7 offset:1664
    ds_read_b32 v23, v7 offset:2496
    s_waitcnt vmcnt(11)
    s_barrier
    s_mov_b32 exec_hi, 0xffff
    s_add_u32 s68, s99, 8
    s_mul_i32 s69, s68, 784
    s_cmp_ge_u32 s68, 26
    s_cselect_b32 s67, 848, 0
    s_add_u32 s69, s69, s67
    s_add_u32 m0, s69, 114688
    s_lshl_b32 s68, s68, 10
    s_add_u32 s68, s68, 655360
    buffer_load_dwordx4 v6, s[48:51], s68 offen sc1 lds
    s_add_u32 s68, s99, 4
    s_mul_i32 s69, s68, 784
    s_cmp_ge_u32 s68, 26
    s_cselect_b32 s67, 848, 0
    s_add_u32 s69, s69, s67
    s_add_u32 m0, s69, 114688
    s_lshl_b32 s68, s68, 10
    s_add_u32 s68, s68, 655360
    buffer_load_dwordx4 v6, s[48:51], s68 offen sc1 lds
    s_add_u32 s68, s99, 0
    s_mul_i32 s69, s68, 784
    s_cmp_ge_u32 s68, 26
    s_cselect_b32 s67, 848, 0
    s_add_u32 s69, s69, s67
    s_add_u32 m0, s69, 114688
    s_lshl_b32 s68, s68, 10
    s_add_u32 s68, s68, 655360
    buffer_load_dwordx4 v6, s[48:51], s68 offen sc1 lds
    s_mov_b64 exec, -1
    s_add_u32 s71, s71, s5
    s_add_u32 m0, s97, 65536
    s_add_u32 s67, s71, 0
    buffer_load_dwordx4 v8, s[36:39], s67 offen  lds
    s_add_u32 m0, s97, 66560
    s_add_u32 s67, s71, 26624
    buffer_load_dwordx4 v8, s[36:39], s67 offen  lds
    s_add_u32 m0, s97, 67584
    s_add_u32 s67, s71, 53248
    buffer_load_dwordx4 v9, s[36:39], s67 offen  lds
    s_add_u32 m0, s97, 68608
    s_add_u32 s67, s71, 79872
    buffer_load_dwordx4 v9, s[36:39], s67 offen  lds
    s_mov_b32 s67, s7
    s_add_u32 m0, s96, 65536
    s_nop 0
    buffer_load_dwordx4 v16, s[32:35], s67 offen  lds
    s_add_u32 m0, s96, 66560
    s_nop 0
    buffer_load_dwordx4 v17, s[32:35], s67 offen  lds
    s_add_u32 m0, s96, 67584
    s_nop 0
    buffer_load_dwordx4 v18, s[32:35], s67 offen  lds
    s_add_u32 m0, s96, 68608
    s_nop 0
    buffer_load_dwordx4 v19, s[32:35], s67 offen  lds
    v_mul_f32 v100, v32, v32
    v_mul_f32 v101, v32, v33
    v_mul_f32 v102, v32, v34
    v_mul_f32 v103, v32, v35
    v_cvt_pk_bf16_f32 v84, v100, v101
    v_mul_f32 v104, v32, v36
    v_mul_f32 v105, v32, v37
    v_cvt_pk_bf16_f32 v85, v102, v103
    v_mul_f32 v106, v32, v38
    v_mul_f32 v107, v32, v39
    v_cvt_pk_bf16_f32 v86, v104, v105
    v_cvt_pk_bf16_f32 v87, v106, v107
    v_mul_f32 v108, v58, v58
    v_mul_f32 v109, v58, v59
    v_mul_f32 v110, v58, v60
    v_mul_f32 v111, v58, v61
    v_cvt_pk_bf16_f32 v88, v108, v109
    v_mul_f32 v112, v58, v62
    v_mul_f32 v113, v58, v63
    v_cvt_pk_bf16_f32 v89, v110, v111
    v_mul_f32 v114, v58, v64
    v_mul_f32 v115, v58, v65
    v_cvt_pk_bf16_f32 v90, v112, v113
    v_cvt_pk_bf16_f32 v91, v114, v115
    s_waitcnt vmcnt(8)
    s_barrier
    s_add_u32 s27, s70, 3
    s_and_b32 s27, s27, 3
    s_add_u32 s27, s27, 8
    s_mul_i32 s71, s27, 851968
    s_add_u32 s71, s71, s98
    s_add_u32 m0, s97, 0
    s_add_u32 s67, s71, 0
    buffer_load_dwordx4 v8, s[36:39], s67 offen  lds
    s_add_u32 m0, s97, 1024
    s_add_u32 s67, s71, 26624
    buffer_load_dwordx4 v8, s[36:39], s67 offen  lds
    s_add_u32 m0, s97, 2048
    s_add_u32 s67, s71, 53248
    buffer_load_dwordx4 v9, s[36:39], s67 offen  lds
    s_add_u32 m0, s97, 3072
    s_add_u32 s67, s71, 79872
    buffer_load_dwordx4 v9, s[36:39], s67 offen  lds
    s_waitcnt lgkmcnt(0)
    v_lshl_add_u32 v20, v20, 8, v4
    v_lshl_add_u32 v21, v21, 8, v5
    v_lshl_add_u32 v22, v22, 8, v4
    v_lshl_add_u32 v23, v23, 8, v5
    s_mov_b32 s67, s6
    s_add_u32 m0, s96, 0
    s_nop 0
    buffer_load_dwordx4 v20, s[32:35], s67 offen  lds
    s_add_u32 m0, s96, 1024
    s_nop 0
    buffer_load_dwordx4 v21, s[32:35], s67 offen  lds
    s_add_u32 m0, s96, 2048
    s_nop 0
    buffer_load_dwordx4 v22, s[32:35], s67 offen  lds
    s_add_u32 m0, s96, 3072
    s_nop 0
    buffer_load_dwordx4 v23, s[32:35], s67 offen  lds
    s_add_u32 s26, s70, 4
    s_and_b32 s26, s26, 3
    s_add_u32 s26, s26, 8
    s_lshl_b32 s26, s26, 2
    v_add_u32 v7, s26, v10
    ds_read_b32 v24, v7 offset:0
    ds_read_b32 v25, v7 offset:832
    ds_read_b32 v26, v7 offset:1664
    ds_read_b32 v27, v7 offset:2496
    ds_read_b128 v[116:119], v219 offset:0
    ds_read_b128 v[120:123], v219 offset:21232
    s_waitcnt vmcnt(8)
    s_barrier
    s_add_u32 s71, s71, s5
    s_add_u32 m0, s97, 32768
    s_add_u32 s67, s71, 0
    buffer_load_dwordx4 v8, s[36:39], s67 offen  lds
    s_nop 0
    s_waitcnt lgkmcnt(0)
    v_mfma_f32_32x32x16_bf16 v[132:147], v[116:119], v[84:87], 0
    ds_read_b128 v[124:127], v219 offset:32
    s_add_u32 m0, s97, 33792
    s_add_u32 s67, s71, 26624
    buffer_load_dwordx4 v8, s[36:39], s67 offen  lds
    ds_read_b128 v[128:131], v219 offset:21264
    v_mul_f32 v100, v32, v40
    v_mul_f32 v101, v32, v41
    v_mul_f32 v102, v32, v42
    s_add_u32 m0, s97, 34816
    s_add_u32 s67, s71, 53248
    buffer_load_dwordx4 v9, s[36:39], s67 offen  lds
    v_mul_f32 v103, v32, v43
    v_mfma_f32_32x32x16_bf16 v[164:179], v[116:119], v[88:91], 0
    v_cvt_pk_bf16_f32 v92, v100, v101
    v_mul_f32 v104, v32, v44
    s_add_u32 m0, s97, 35840
    s_add_u32 s67, s71, 79872
    buffer_load_dwordx4 v9, s[36:39], s67 offen  lds
    v_mul_f32 v105, v32, v45
    v_cvt_pk_bf16_f32 v93, v102, v103
    v_mul_f32 v106, v34, v34
    v_mul_f32 v107, v34, v35
    s_mov_b32 s67, s7
    s_add_u32 m0, s96, 32768
    s_nop 0
    buffer_load_dwordx4 v20, s[32:35], s67 offen  lds
    v_cvt_pk_bf16_f32 v94, v104, v105
    v_mfma_f32_32x32x16_bf16 v[148:163], v[120:123], v[84:87], v[196:211]
    v_cvt_pk_bf16_f32 v95, v106, v107
    v_mul_f32 v108, v58, v66
    s_add_u32 m0, s96, 33792
    s_nop 0
    buffer_load_dwordx4 v21, s[32:35], s67 offen  lds
    v_mul_f32 v109, v58, v67
    v_mul_f32 v110, v58, v68
    v_mul_f32 v111, v58, v69
    v_cvt_pk_bf16_f32 v96, v108, v109
    s_add_u32 m0, s96, 34816
    s_nop 0
    buffer_load_dwordx4 v22, s[32:35], s67 offen  lds
    v_mfma_f32_32x32x16_bf16 v[180:195], v[120:123], v[88:91], v[196:211]
    v_mul_f32 v112, v58, v70
    v_mul_f32 v113, v58, v71
    v_cvt_pk_bf16_f32 v97, v110, v111
    s_add_u32 m0, s96, 35840
    s_nop 0
    buffer_load_dwordx4 v23, s[32:35], s67 offen  lds
    v_mul_f32 v114, v60, v60
    v_mul_f32 v115, v60, v61
    v_cvt_pk_bf16_f32 v98, v112, v113
    v_cvt_pk_bf16_f32 v99, v114, v115
    s_waitcnt vmcnt(8)
    s_barrier
    s_add_u32 s27, s70, 4
    s_and_b32 s27, s27, 3
    s_add_u32 s27, s27, 8
    s_mul_i32 s71, s27, 851968
    s_add_u32 s71, s71, s98
    s_add_u32 m0, s97, 65536
    s_add_u32 s67, s71, 0
    buffer_load_dwordx4 v8, s[36:39], s67 offen  lds
    s_nop 0
    s_waitcnt lgkmcnt(0)
    v_mfma_f32_32x32x16_bf16 v[132:147], v[124:127], v[92:95], v[132:147]
    ds_read_b128 v[116:119], v219 offset:64
    s_add_u32 m0, s97, 66560
    s_add_u32 s67, s71, 26624
    buffer_load_dwordx4 v8, s[36:39], s67 offen  lds
    ds_read_b128 v[120:123], v219 offset:21296
    v_mul_f32 v100, v34, v36
    v_mul_f32 v101, v34, v37
    v_mul_f32 v102, v34, v38
    s_add_u32 m0, s97, 67584
    s_add_u32 s67, s71, 53248
    buffer_load_dwordx4 v9, s[36:39], s67 offen  lds
    v_mul_f32 v103, v34, v39
    v_mfma_f32_32x32x16_bf16 v[164:179], v[124:127], v[96:99], v[164:179]
    v_cvt_pk_bf16_f32 v84, v100, v101
    v_mul_f32 v104, v34, v40
    s_add_u32 m0, s97, 68608
    s_add_u32 s67, s71, 79872
    buffer_load_dwordx4 v9, s[36:39], s67 offen  lds
    v_mul_f32 v105, v34, v41
    v_cvt_pk_bf16_f32 v85, v102, v103
    v_mul_f32 v106, v34, v42
    v_mul_f32 v107, v34, v43
    s_waitcnt lgkmcnt(0)
    v_lshl_add_u32 v24, v24, 8, v4
    v_lshl_add_u32 v25, v25, 8, v5
    v_lshl_add_u32 v26, v26, 8, v4
    v_lshl_add_u32 v27, v27, 8, v5
    s_mov_b32 s67, s6
    s_add_u32 m0, s96, 65536
    s_nop 0
    buffer_load_dwordx4 v24, s[32:35], s67 offen  lds
    v_cvt_pk_bf16_f32 v86, v104, v105
    v_mfma_f32_32x32x16_bf16 v[148:163], v[128:131], v[92:95], v[148:163]
    v_cvt_pk_bf16_f32 v87, v106, v107
    v_mul_f32 v108, v60, v62
    s_add_u32 m0, s96, 66560
    s_nop 0
    buffer_load_dwordx4 v25, s[32:35], s67 offen  lds
    v_mul_f32 v109, v60, v63
    v_mul_f32 v110, v60, v64
    v_mul_f32 v111, v60, v65
    v_cvt_pk_bf16_f32 v88, v108, v109
    s_add_u32 m0, s96, 67584
    s_nop 0
    buffer_load_dwordx4 v26, s[32:35], s67 offen  lds
    v_mfma_f32_32x32x16_bf16 v[180:195], v[128:131], v[96:99], v[180:195]
    v_mul_f32 v112, v60, v66
    v_mul_f32 v113, v60, v67
    v_cvt_pk_bf16_f32 v89, v110, v111
    s_add_u32 m0, s96, 68608
    s_nop 0
    buffer_load_dwordx4 v27, s[32:35], s67 offen  lds
    v_mul_f32 v114, v60, v68
    v_mul_f32 v115, v60, v69
    v_cvt_pk_bf16_f32 v90, v112, v113
    v_cvt_pk_bf16_f32 v91, v114, v115
    s_add_u32 s26, s70, 5
    s_and_b32 s26, s26, 3
    s_add_u32 s26, s26, 8
    s_lshl_b32 s26, s26, 2
    v_add_u32 v7, s26, v10
    ds_read_b32 v28, v7 offset:0
    ds_read_b32 v29, v7 offset:832
    ds_read_b32 v30, v7 offset:1664
    ds_read_b32 v31, v7 offset:2496
    s_waitcnt vmcnt(8)
    s_barrier
    s_add_u32 s71, s71, s5
    s_add_u32 m0, s97, 0
    s_add_u32 s67, s71, 0
    buffer_load_dwordx4 v8, s[36:39], s67 offen  lds
    s_nop 0
    s_waitcnt lgkmcnt(0)
    v_mfma_f32_32x32x16_bf16 v[132:147], v[116:119], v[84:87], v[132:147]
    ds_read_b128 v[124:127], v219 offset:96
    s_add_u32 m0, s97, 1024
    s_add_u32 s67, s71, 26624
    buffer_load_dwordx4 v8, s[36:39], s67 offen  lds
    ds_read_b128 v[128:131], v219 offset:21328
    v_mul_f32 v100, v34, v44
    v_mul_f32 v101, v34, v45
    v_mul_f32 v102, v34, v46
    s_add_u32 m0, s97, 2048
    s_add_u32 s67, s71, 53248
    buffer_load_dwordx4 v9, s[36:39], s67 offen  lds
    v_mul_f32 v103, v34, v47
    v_mfma_f32_32x32x16_bf16 v[164:179], v[116:119], v[88:91], v[164:179]
    v_cvt_pk_bf16_f32 v92, v100, v101
    v_mul_f32 v104, v36, v36
    s_add_u32 m0, s97, 3072
    s_add_u32 s67, s71, 79872
    buffer_load_dwordx4 v9, s[36:39], s67 offen  lds
    v_mul_f32 v105, v36, v37
    v_cvt_pk_bf16_f32 v93, v102, v103
    v_mul_f32 v106, v36, v38
    v_mul_f32 v107, v36, v39
    s_mov_b32 s67, s7
    s_add_u32 m0, s96, 0
    s_nop 0
    buffer_load_dwordx4 v24, s[32:35], s67 offen  lds
    v_cvt_pk_bf16_f32 v94, v104, v105
    v_mfma_f32_32x32x16_bf16 v[148:163], v[120:123], v[84:87], v[148:163]
    v_cvt_pk_bf16_f32 v95, v106, v107
    v_mul_f32 v108, v60, v70
    s_add_u32 m0, s96, 1024
    s_nop 0
    buffer_load_dwordx4 v25, s[32:35], s67 offen  lds
    v_mul_f32 v109, v60, v71
    v_mul_f32 v110, v60, v72
    v_mul_f32 v111, v60, v73
    v_cvt_pk_bf16_f32 v96, v108, v109
    s_add_u32 m0, s96, 2048
    s_nop 0
    buffer_load_dwordx4 v26, s[32:35], s67 offen  lds
    v_mfma_f32_32x32x16_bf16 v[180:195], v[120:123], v[88:91], v[180:195]
    v_mul_f32 v112, v62, v62
    v_mul_f32 v113, v62, v63
    v_cvt_pk_bf16_f32 v97, v110, v111
    s_add_u32 m0, s96, 3072
    s_nop 0
    buffer_load_dwordx4 v27, s[32:35], s67 offen  lds
    v_mul_f32 v114, v62, v64
    v_mul_f32 v115, v62, v65
    v_cvt_pk_bf16_f32 v98, v112, v113
    v_cvt_pk_bf16_f32 v99, v114, v115
    s_waitcnt vmcnt(8)
    s_barrier
    s_add_u32 s27, s70, 5
    s_and_b32 s27, s27, 3
    s_add_u32 s27, s27, 8
    s_mul_i32 s71, s27, 851968
    s_add_u32 s71, s71, s98
    s_add_u32 m0, s97, 32768
    s_add_u32 s67, s71, 0
    buffer_load_dwordx4 v8, s[36:39], s67 offen  lds
    s_nop 0
    s_waitcnt lgkmcnt(0)
    v_mfma_f32_32x32x16_bf16 v[132:147], v[124:127], v[92:95], v[132:147]
    ds_read_b128 v[116:119], v219 offset:128
    s_add_u32 m0, s97, 33792
    s_add_u32 s67, s71, 26624
    buffer_load_dwordx4 v8, s[36:39], s67 offen  lds
    ds_read_b128 v[120:123], v219 offset:21360
    v_mul_f32 v100, v36, v40
    v_mul_f32 v101, v36, v41
    v_mul_f32 v102, v36, v42
    s_add_u32 m0, s97, 34816
    s_add_u32 s67, s71, 53248
    buffer_load_dwordx4 v9, s[36:39], s67 offen  lds
    v_mul_f32 v103, v36, v43
    v_mfma_f32_32x32x16_bf16 v[164:179], v[124:127], v[96:99], v[164:179]
    v_cvt_pk_bf16_f32 v84, v100, v101
    v_mul_f32 v104, v36, v44
    s_add_u32 m0, s97, 35840
    s_add_u32 s67, s71, 79872
    buffer_load_dwordx4 v9, s[36:39], s67 offen  lds
    v_mul_f32 v105, v36, v45
    v_cvt_pk_bf16_f32 v85, v102, v103
    v_mul_f32 v106, v36, v46
    v_mul_f32 v107, v36, v47
    s_waitcnt lgkmcnt(0)
    v_lshl_add_u32 v28, v28, 8, v4
    v_lshl_add_u32 v29, v29, 8, v5
    v_lshl_add_u32 v30, v30, 8, v4
    v_lshl_add_u32 v31, v31, 8, v5
    s_mov_b32 s67, s6
    s_add_u32 m0, s96, 32768
    s_nop 0
    buffer_load_dwordx4 v28, s[32:35], s67 offen  lds
    v_cvt_pk_bf16_f32 v86, v104, v105
    v_mfma_f32_32x32x16_bf16 v[148:163], v[128:131], v[92:95], v[148:163]
    v_cvt_pk_bf16_f32 v87, v106, v107
    v_mul_f32 v108, v62, v66
    s_add_u32 m0, s96, 33792
    s_nop 0
    buffer_load_dwordx4 v29, s[32:35], s67 offen  lds
    v_mul_f32 v109, v62, v67
    v_mul_f32 v110, v62, v68
    v_mul_f32 v111, v62, v69
    v_cvt_pk_bf16_f32 v88, v108, v109
    s_add_u32 m0, s96, 34816
    s_nop 0
    buffer_load_dwordx4 v30, s[32:35], s67 offen  lds
    v_mfma_f32_32x32x16_bf16 v[180:195], v[128:131], v[96:99], v[180:195]
    v_mul_f32 v112, v62, v70
    v_mul_f32 v113, v62, v71
    v_cvt_pk_bf16_f32 v89, v110, v111
    s_add_u32 m0, s96, 35840
    s_nop 0
    buffer_load_dwordx4 v31, s[32:35], s67 offen  lds
    v_mul_f32 v114, v62, v72
    v_mul_f32 v115, v62, v73
    v_cvt_pk_bf16_f32 v90, v112, v113
    v_cvt_pk_bf16_f32 v91, v114, v115
    s_add_u32 s26, s70, 3
    s_and_b32 s26, s26, 3
    s_add_u32 s26, s26, 12
    s_lshl_b32 s26, s26, 2
    v_add_u32 v7, s26, v10
    ds_read_b32 v16, v7 offset:0
    ds_read_b32 v17, v7 offset:832
    ds_read_b32 v18, v7 offset:1664
    ds_read_b32 v19, v7 offset:2496
    s_waitcnt vmcnt(8)
    s_barrier
    s_add_u32 s71, s71, s5
    s_add_u32 m0, s97, 65536
    s_add_u32 s67, s71, 0
    buffer_load_dwordx4 v8, s[36:39], s67 offen  lds
    s_add_u32 m0, s97, 66560
    s_add_u32 s67, s71, 26624
    buffer_load_dwordx4 v8, s[36:39], s67 offen  lds
    s_add_u32 m0, s97, 67584
    s_add_u32 s67, s71, 53248
    buffer_load_dwordx4 v9, s[36:39], s67 offen  lds
    s_add_u32 m0, s97, 68608
    s_add_u32 s67, s71, 79872
    buffer_load_dwordx4 v9, s[36:39], s67 offen  lds
    s_mov_b32 s67, s7
    s_add_u32 m0, s96, 65536
    s_nop 0
    buffer_load_dwordx4 v28, s[32:35], s67 offen  lds
    s_add_u32 m0, s96, 66560
    s_nop 0
    buffer_load_dwordx4 v29, s[32:35], s67 offen  lds
    s_add_u32 m0, s96, 67584
    s_nop 0
    buffer_load_dwordx4 v30, s[32:35], s67 offen  lds
    s_add_u32 m0, s96, 68608
    s_nop 0
    buffer_load_dwordx4 v31, s[32:35], s67 offen  lds
    s_waitcnt vmcnt(8)
    s_barrier
    s_add_u32 s27, s70, 3
    s_and_b32 s27, s27, 3
    s_add_u32 s27, s27, 12
    s_mul_i32 s71, s27, 851968
    s_add_u32 s71, s71, s98
    s_add_u32 m0, s97, 0
    s_add_u32 s67, s71, 0
    buffer_load_dwordx4 v8, s[36:39], s67 offen  lds
    s_nop 0
    s_waitcnt lgkmcnt(0)
    v_mfma_f32_32x32x16_bf16 v[132:147], v[116:119], v[84:87], v[132:147]
    ds_read_b128 v[124:127], v219 offset:160
    s_add_u32 m0, s97, 1024
    s_add_u32 s67, s71, 26624
    buffer_load_dwordx4 v8, s[36:39], s67 offen  lds
    ds_read_b128 v[128:131], v219 offset:21392
    v_mul_f32 v100, v36, v48
    v_mul_f32 v101, v36, v49
    v_mul_f32 v102, v38, v38
    s_add_u32 m0, s97, 2048
    s_add_u32 s67, s71, 53248
    buffer_load_dwordx4 v9, s[36:39], s67 offen  lds
    v_mul_f32 v103, v38, v39
    v_mfma_f32_32x32x16_bf16 v[164:179], v[116:119], v[88:91], v[164:179]
    v_cvt_pk_bf16_f32 v92, v100, v101
    v_mul_f32 v104, v38, v40
    s_add_u32 m0, s97, 3072
    s_add_u32 s67, s71, 79872
    buffer_load_dwordx4 v9, s[36:39], s67 offen  lds
    v_mul_f32 v105, v38, v41
    v_cvt_pk_bf16_f32 v93, v102, v103
    v_mul_f32 v106, v38, v42
    v_mul_f32 v107, v38, v43
    s_waitcnt lgkmcnt(0)
    v_lshl_add_u32 v16, v16, 8, v4
    v_lshl_add_u32 v17, v17, 8, v5
    v_lshl_add_u32 v18, v18, 8, v4
    v_lshl_add_u32 v19, v19, 8, v5
    s_mov_b32 s67, s6
    s_add_u32 m0, s96, 0
    s_nop 0
    buffer_load_dwordx4 v16, s[32:35], s67 offen  lds
    v_cvt_pk_bf16_f32 v94, v104, v105
    v_mfma_f32_32x32x16_bf16 v[148:163], v[120:123], v[84:87], v[148:163]
    v_cvt_pk_bf16_f32 v95, v106, v107
    v_mul_f32 v108, v62, v74
    s_add_u32 m0, s96, 1024
    s_nop 0
    buffer_load_dwordx4 v17, s[32:35], s67 offen  lds
    v_mul_f32 v109, v62, v75
    v_mul_f32 v110, v64, v64
    v_mul_f32 v111, v64, v65
    v_cvt_pk_bf16_f32 v96, v108, v109
    s_add_u32 m0, s96, 2048
    s_nop 0
    buffer_load_dwordx4 v18, s[32:35], s67 offen  lds
    v_mfma_f32_32x32x16_bf16 v[180:195], v[120:123], v[88:91], v[180:195]
    v_mul_f32 v112, v64, v66
    v_mul_f32 v113, v64, v67
    v_cvt_pk_bf16_f32 v97, v110, v111
    s_add_u32 m0, s96, 3072
    s_nop 0
    buffer_load_dwordx4 v19, s[32:35], s67 offen  lds
    v_mul_f32 v114, v64, v68
    v_mul_f32 v115, v64, v69
    v_cvt_pk_bf16_f32 v98, v112, v113
    v_cvt_pk_bf16_f32 v99, v114, v115
    s_add_u32 s26, s70, 4
    s_and_b32 s26, s26, 3
    s_add_u32 s26, s26, 12
    s_lshl_b32 s26, s26, 2
    v_add_u32 v7, s26, v10
    ds_read_b32 v20, v7 offset:0
    ds_read_b32 v21, v7 offset:832
    ds_read_b32 v22, v7 offset:1664
    ds_read_b32 v23, v7 offset:2496
    s_waitcnt vmcnt(8)
    s_barrier
    s_add_u32 s71, s71, s5
    s_add_u32 m0, s97, 32768
    s_add_u32 s67, s71, 0
    buffer_load_dwordx4 v8, s[36:39], s67 offen  lds
    s_nop 0
    s_waitcnt lgkmcnt(0)
    v_mfma_f32_32x32x16_bf16 v[132:147], v[124:127], v[92:95], v[132:147]
    ds_read_b128 v[116:119], v219 offset:192
    s_add_u32 m0, s97, 33792
    s_add_u32 s67, s71, 26624
    buffer_load_dwordx4 v8, s[36:39], s67 offen  lds
    ds_read_b128 v[120:123], v219 offset:21424
    v_mul_f32 v100, v38, v44
    v_mul_f32 v101, v38, v45
    v_mul_f32 v102, v38, v46
    s_add_u32 m0, s97, 34816
    s_add_u32 s67, s71, 53248
    buffer_load_dwordx4 v9, s[36:39], s67 offen  lds
    v_mul_f32 v103, v38, v47
    v_mfma_f32_32x32x16_bf16 v[164:179], v[124:127], v[96:99], v[164:179]
    v_cvt_pk_bf16_f32 v84, v100, v101
    v_mul_f32 v104, v38, v48
    s_add_u32 m0, s97, 35840
    s_add_u32 s67, s71, 79872
    buffer_load_dwordx4 v9, s[36:39], s67 offen  lds
    v_mul_f32 v105, v38, v49
    v_cvt_pk_bf16_f32 v85, v102, v103
    v_mul_f32 v106, v38, v50
    v_mul_f32 v107, v38, v51
    s_mov_b32 s67, s7
    s_add_u32 m0, s96, 32768
    s_nop 0
    buffer_load_dwordx4 v16, s[32:35], s67 offen  lds
    v_cvt_pk_bf16_f32 v86, v104, v105
    v_mfma_f32_32x32x16_bf16 v[148:163], v[128:131], v[92:95], v[148:163]
    v_cvt_pk_bf16_f32 v87, v106, v107
    v_mul_f32 v108, v64, v70
    s_add_u32 m0, s96, 33792
    s_nop 0
    buffer_load_dwordx4 v17, s[32:35], s67 offen  lds
    v_mul_f32 v109, v64, v71
    v_mul_f32 v110, v64, v72
    v_mul_f32 v111, v64, v73
    v_cvt_pk_bf16_f32 v88, v108, v109
    s_add_u32 m0, s96, 34816
    s_nop 0
    buffer_load_dwordx4 v18, s[32:35], s67 offen  lds
    v_mfma_f32_32x32x16_bf16 v[180:195], v[128:131], v[96:99], v[180:195]
    v_mul_f32 v112, v64, v74
    v_mul_f32 v113, v64, v75
    v_cvt_pk_bf16_f32 v89, v110, v111
    s_add_u32 m0, s96, 35840
    s_nop 0
    buffer_load_dwordx4 v19, s[32:35], s67 offen  lds
    v_mul_f32 v114, v64, v76
    v_mul_f32 v115, v64, v77
    v_cvt_pk_bf16_f32 v90, v112, v113
    v_cvt_pk_bf16_f32 v91, v114, v115
    s_waitcnt vmcnt(8)
    s_barrier
    s_add_u32 s27, s70, 4
    s_and_b32 s27, s27, 3
    s_add_u32 s27, s27, 12
    s_mul_i32 s71, s27, 851968
    s_add_u32 s71, s71, s98
    s_add_u32 m0, s97, 65536
    s_add_u32 s67, s71, 0
    buffer_load_dwordx4 v8, s[36:39], s67 offen  lds
    s_nop 0
    s_waitcnt lgkmcnt(0)
    v_mfma_f32_32x32x16_bf16 v[132:147], v[116:119], v[84:87], v[132:147]
    ds_read_b128 v[124:127], v219 offset:224
    s_add_u32 m0, s97, 66560
    s_add_u32 s67, s71, 26624
    buffer_load_dwordx4 v8, s[36:39], s67 offen  lds
    ds_read_b128 v[128:131], v219 offset:21456
    v_mul_f32 v100, v40, v40
    v_mul_f32 v101, v40, v41
    v_mul_f32 v102, v40, v42
    s_add_u32 m0, s97, 67584
    s_add_u32 s67, s71, 53248
    buffer_load_dwordx4 v9, s[36:39], s67 offen  lds
    v_mul_f32 v103, v40, v43
    v_mfma_f32_32x32x16_bf16 v[164:179], v[116:119], v[88:91], v[164:179]
    v_cvt_pk_bf16_f32 v92, v100, v101
    v_mul_f32 v104, v40, v44
    s_add_u32 m0, s97, 68608
    s_add_u32 s67, s71, 79872
    buffer_load_dwordx4 v9, s[36:39], s67 offen  lds
    v_mul_f32 v105, v40, v45
    v_cvt_pk_bf16_f32 v93, v102, v103
    v_mul_f32 v106, v40, v46
    v_mul_f32 v107, v40, v47
    s_waitcnt lgkmcnt(0)
    v_lshl_add_u32 v20, v20, 8, v4
    v_lshl_add_u32 v21, v21, 8, v5
    v_lshl_add_u32 v22, v22, 8, v4
    v_lshl_add_u32 v23, v23, 8, v5
    s_mov_b32 s67, s6
    s_add_u32 m0, s96, 65536
    s_nop 0
    buffer_load_dwordx4 v20, s[32:35], s67 offen  lds
    v_cvt_pk_bf16_f32 v94, v104, v105
    v_mfma_f32_32x32x16_bf16 v[148:163], v[120:123], v[84:87], v[148:163]
    v_cvt_pk_bf16_f32 v95, v106, v107
    v_mul_f32 v108, v66, v66
    s_add_u32 m0, s96, 66560
    s_nop 0
    buffer_load_dwordx4 v21, s[32:35], s67 offen  lds
    v_mul_f32 v109, v66, v67
    v_mul_f32 v110, v66, v68
    v_mul_f32 v111, v66, v69
    v_cvt_pk_bf16_f32 v96, v108, v109
    s_add_u32 m0, s96, 67584
    s_nop 0
    buffer_load_dwordx4 v22, s[32:35], s67 offen  lds
    v_mfma_f32_32x32x16_bf16 v[180:195], v[120:123], v[88:91], v[180:195]
    v_mul_f32 v112, v66, v70
    v_mul_f32 v113, v66, v71
    v_cvt_pk_bf16_f32 v97, v110, v111
    s_add_u32 m0, s96, 68608
    s_nop 0
    buffer_load_dwordx4 v23, s[32:35], s67 offen  lds
    v_mul_f32 v114, v66, v72
    v_mul_f32 v115, v66, v73
    v_cvt_pk_bf16_f32 v98, v112, v113
    v_cvt_pk_bf16_f32 v99, v114, v115
    s_add_u32 s26, s70, 5
    s_and_b32 s26, s26, 3
    s_add_u32 s26, s26, 12
    s_lshl_b32 s26, s26, 2
    v_add_u32 v7, s26, v10
    ds_read_b32 v24, v7 offset:0
    ds_read_b32 v25, v7 offset:832
    ds_read_b32 v26, v7 offset:1664
    ds_read_b32 v27, v7 offset:2496
    s_waitcnt vmcnt(8)
    s_barrier
    s_add_u32 s71, s71, s5
    s_add_u32 m0, s97, 0
    s_add_u32 s67, s71, 0
    buffer_load_dwordx4 v8, s[36:39], s67 offen  lds
    s_nop 0
    s_waitcnt lgkmcnt(0)
    v_mfma_f32_32x32x16_bf16 v[132:147], v[124:127], v[92:95], v[132:147]
    ds_read_b128 v[116:119], v219 offset:256
    s_add_u32 m0, s97, 1024
    s_add_u32 s67, s71, 26624
    buffer_load_dwordx4 v8, s[36:39], s67 offen  lds
    ds_read_b128 v[120:123], v219 offset:21488
    v_mul_f32 v100, v40, v48
    v_mul_f32 v101, v40, v49
    v_mul_f32 v102, v40, v50
    s_add_u32 m0, s97, 2048
    s_add_u32 s67, s71, 53248
    buffer_load_dwordx4 v9, s[36:39], s67 offen  lds
    v_mul_f32 v103, v40, v51
    v_mfma_f32_32x32x16_bf16 v[164:179], v[124:127], v[96:99], v[164:179]
    v_cvt_pk_bf16_f32 v84, v100, v101
    v_mul_f32 v104, v40, v52
    s_add_u32 m0, s97, 3072
    s_add_u32 s67, s71, 79872
    buffer_load_dwordx4 v9, s[36:39], s67 offen  lds
    v_mul_f32 v105, v40, v53
    v_cvt_pk_bf16_f32 v85, v102, v103
    v_mul_f32 v106, v42, v42
    v_mul_f32 v107, v42, v43
    s_mov_b32 s67, s7
    s_add_u32 m0, s96, 0
    s_nop 0
    buffer_load_dwordx4 v20, s[32:35], s67 offen  lds
    v_cvt_pk_bf16_f32 v86, v104, v105
    v_mfma_f32_32x32x16_bf16 v[148:163], v[128:131], v[92:95], v[148:163]
    v_cvt_pk_bf16_f32 v87, v106, v107
    v_mul_f32 v108, v66, v74
    s_add_u32 m0, s96, 1024
    s_nop 0
    buffer_load_dwordx4 v21, s[32:35], s67 offen  lds
    v_mul_f32 v109, v66, v75
    v_mul_f32 v110, v66, v76
    v_mul_f32 v111, v66, v77
    v_cvt_pk_bf16_f32 v88, v108, v109
    s_add_u32 m0, s96, 2048
    s_nop 0
    buffer_load_dwordx4 v22, s[32:35], s67 offen  lds
    v_mfma_f32_32x32x16_bf16 v[180:195], v[128:131], v[96:99], v[180:195]
    v_mul_f32 v112, v66, v78
    v_mul_f32 v113, v66, v79
    v_cvt_pk_bf16_f32 v89, v110, v111
    s_add_u32 m0, s96, 3072
    s_nop 0
    buffer_load_dwordx4 v23, s[32:35], s67 offen  lds
    v_mul_f32 v114, v68, v68
    v_mul_f32 v115, v68, v69
    v_cvt_pk_bf16_f32 v90, v112, v113
    v_cvt_pk_bf16_f32 v91, v114, v115
    s_waitcnt vmcnt(8)
    s_barrier
    s_add_u32 s27, s70, 5
    s_and_b32 s27, s27, 3
    s_add_u32 s27, s27, 12
    s_mul_i32 s71, s27, 851968
    s_add_u32 s71, s71, s98
    s_add_u32 m0, s97, 32768
    s_add_u32 s67, s71, 0
    buffer_load_dwordx4 v8, s[36:39], s67 offen  lds
    s_add_u32 m0, s97, 33792
    s_add_u32 s67, s71, 26624
    buffer_load_dwordx4 v8, s[36:39], s67 offen  lds
    s_add_u32 m0, s97, 34816
    s_add_u32 s67, s71, 53248
    buffer_load_dwordx4 v9, s[36:39], s67 offen  lds
    s_add_u32 m0, s97, 35840
    s_add_u32 s67, s71, 79872
    buffer_load_dwordx4 v9, s[36:39], s67 offen  lds
    s_waitcnt lgkmcnt(0)
    v_lshl_add_u32 v24, v24, 8, v4
    v_lshl_add_u32 v25, v25, 8, v5
    v_lshl_add_u32 v26, v26, 8, v4
    v_lshl_add_u32 v27, v27, 8, v5
    s_mov_b32 s67, s6
    s_add_u32 m0, s96, 32768
    s_nop 0
    buffer_load_dwordx4 v24, s[32:35], s67 offen  lds
    s_add_u32 m0, s96, 33792
    s_nop 0
    buffer_load_dwordx4 v25, s[32:35], s67 offen  lds
    s_add_u32 m0, s96, 34816
    s_nop 0
    buffer_load_dwordx4 v26, s[32:35], s67 offen  lds
    s_add_u32 m0, s96, 35840
    s_nop 0
    buffer_load_dwordx4 v27, s[32:35], s67 offen  lds
    s_add_u32 s26, s70, 6
    s_and_b32 s26, s26, 3
    s_add_u32 s26, s26, 12
    s_lshl_b32 s26, s26, 2
    v_add_u32 v7, s26, v10
    ds_read_b32 v28, v7 offset:0
    ds_read_b32 v29, v7 offset:832
    ds_read_b32 v30, v7 offset:1664
    ds_read_b32 v31, v7 offset:2496
    s_waitcnt vmcnt(8)
    s_barrier
    s_add_u32 s71, s71, s5
    s_add_u32 m0, s97, 65536
    s_add_u32 s67, s71, 0
    buffer_load_dwordx4 v8, s[36:39], s67 offen  lds
    s_nop 0
    s_waitcnt lgkmcnt(0)
    v_mfma_f32_32x32x16_bf16 v[132:147], v[116:119], v[84:87], v[132:147]
    ds_read_b128 v[124:127], v219 offset:288
    s_add_u32 m0, s97, 66560
    s_add_u32 s67, s71, 26624
    buffer_load_dwordx4 v8, s[36:39], s67 offen  lds
    ds_read_b128 v[128:131], v219 offset:21520
    v_mul_f32 v100, v42, v44
    v_mul_f32 v101, v42, v45
    v_mul_f32 v102, v42, v46
    s_add_u32 m0, s97, 67584
    s_add_u32 s67, s71, 53248
    buffer_load_dwordx4 v9, s[36:39], s67 offen  lds
    v_mul_f32 v103, v42, v47
    v_mfma_f32_32x32x16_bf16 v[164:179], v[116:119], v[88:91], v[164:179]
    v_cvt_pk_bf16_f32 v92, v100, v101
    v_mul_f32 v104, v42, v48
    s_add_u32 m0, s97, 68608
    s_add_u32 s67, s71, 79872
    buffer_load_dwordx4 v9, s[36:39], s67 offen  lds
    v_mul_f32 v105, v42, v49
    v_cvt_pk_bf16_f32 v93, v102, v103
    v_mul_f32 v106, v42, v50
    v_mul_f32 v107, v42, v51
    s_mov_b32 s67, s7
    s_add_u32 m0, s96, 65536
    s_nop 0
    buffer_load_dwordx4 v24, s[32:35], s67 offen  lds
    v_cvt_pk_bf16_f32 v94, v104, v105
    v_mfma_f32_32x32x16_bf16 v[148:163], v[120:123], v[84:87], v[148:163]
    v_cvt_pk_bf16_f32 v95, v106, v107
    v_mul_f32 v108, v68, v70
    s_add_u32 m0, s96, 66560
    s_nop 0
    buffer_load_dwordx4 v25, s[32:35], s67 offen  lds
    v_mul_f32 v109, v68, v71
    v_mul_f32 v110, v68, v72
    v_mul_f32 v111, v68, v73
    v_cvt_pk_bf16_f32 v96, v108, v109
    s_add_u32 m0, s96, 67584
    s_nop 0
    buffer_load_dwordx4 v26, s[32:35], s67 offen  lds
    v_mfma_f32_32x32x16_bf16 v[180:195], v[120:123], v[88:91], v[180:195]
    v_mul_f32 v112, v68, v74
    v_mul_f32 v113, v68, v75
    v_cvt_pk_bf16_f32 v97, v110, v111
    s_add_u32 m0, s96, 68608
    s_nop 0
    buffer_load_dwordx4 v27, s[32:35], s67 offen  lds
    v_mul_f32 v114, v68, v76
    v_mul_f32 v115, v68, v77
    v_cvt_pk_bf16_f32 v98, v112, v113
    v_cvt_pk_bf16_f32 v99, v114, v115
    s_waitcnt vmcnt(8)
    s_barrier
    s_add_u32 s27, s70, 6
    s_and_b32 s27, s27, 3
    s_add_u32 s27, s27, 12
    s_mul_i32 s71, s27, 851968
    s_add_u32 s71, s71, s98
    s_add_u32 m0, s97, 0
    s_add_u32 s67, s71, 0
    buffer_load_dwordx4 v8, s[36:39], s67 offen  lds
    s_nop 0
    s_waitcnt lgkmcnt(0)
    v_mfma_f32_32x32x16_bf16 v[132:147], v[124:127], v[92:95], v[132:147]
    ds_read_b128 v[116:119], v219 offset:320
    s_add_u32 m0, s97, 1024
    s_add_u32 s67, s71, 26624
    buffer_load_dwordx4 v8, s[36:39], s67 offen  lds
    ds_read_b128 v[120:123], v219 offset:21552
    v_mul_f32 v100, v42, v52
    v_mul_f32 v101, v42, v53
    v_mul_f32 v102, v42, v54
    s_add_u32 m0, s97, 2048
    s_add_u32 s67, s71, 53248
    buffer_load_dwordx4 v9, s[36:39], s67 offen  lds
    v_mul_f32 v103, v42, v55
    v_mfma_f32_32x32x16_bf16 v[164:179], v[124:127], v[96:99], v[164:179]
    v_cvt_pk_bf16_f32 v84, v100, v101
    v_mul_f32 v104, v44, v44
    s_add_u32 m0, s97, 3072
    s_add_u32 s67, s71, 79872
    buffer_load_dwordx4 v9, s[36:39], s67 offen  lds
    v_mul_f32 v105, v44, v45
    v_cvt_pk_bf16_f32 v85, v102, v103
    v_mul_f32 v106, v44, v46
    v_mul_f32 v107, v44, v47
    s_waitcnt lgkmcnt(0)
    v_lshl_add_u32 v28, v28, 8, v4
    v_lshl_add_u32 v29, v29, 8, v5
    v_lshl_add_u32 v30, v30, 8, v4
    v_lshl_add_u32 v31, v31, 8, v5
    s_mov_b32 s67, s6
    s_add_u32 m0, s96, 0
    s_nop 0
    buffer_load_dwordx4 v28, s[32:35], s67 offen  lds
    v_cvt_pk_bf16_f32 v86, v104, v105
    v_mfma_f32_32x32x16_bf16 v[148:163], v[128:131], v[92:95], v[148:163]
    v_cvt_pk_bf16_f32 v87, v106, v107
    v_mul_f32 v108, v68, v78
    s_add_u32 m0, s96, 1024
    s_nop 0
    buffer_load_dwordx4 v29, s[32:35], s67 offen  lds
    v_mul_f32 v109, v68, v79
    v_mul_f32 v110, v68, v80
    v_mul_f32 v111, v68, v81
    v_cvt_pk_bf16_f32 v88, v108, v109
    s_add_u32 m0, s96, 2048
    s_nop 0
    buffer_load_dwordx4 v30, s[32:35], s67 offen  lds
    v_mfma_f32_32x32x16_bf16 v[180:195], v[128:131], v[96:99], v[180:195]
    v_mul_f32 v112, v70, v70
    v_mul_f32 v113, v70, v71
    v_cvt_pk_bf16_f32 v89, v110, v111
    s_add_u32 m0, s96, 3072
    s_nop 0
    buffer_load_dwordx4 v31, s[32:35], s67 offen  lds
    v_mul_f32 v114, v70, v72
    v_mul_f32 v115, v70, v73
    v_cvt_pk_bf16_f32 v90, v112, v113
    v_cvt_pk_bf16_f32 v91, v114, v115
    s_add_u32 s26, s70, 4
    s_and_b32 s26, s26, 3
    s_add_u32 s26, s26, 16
    s_lshl_b32 s26, s26, 2
    v_add_u32 v7, s26, v10
    ds_read_b32 v16, v7 offset:0
    ds_read_b32 v17, v7 offset:832
    ds_read_b32 v18, v7 offset:1664
    ds_read_b32 v19, v7 offset:2496
    s_waitcnt vmcnt(8)
    s_barrier
    s_add_u32 s71, s71, s5
    s_add_u32 m0, s97, 32768
    s_add_u32 s67, s71, 0
    buffer_load_dwordx4 v8, s[36:39], s67 offen  lds
    s_nop 0
    s_waitcnt lgkmcnt(0)
    v_mfma_f32_32x32x16_bf16 v[132:147], v[116:119], v[84:87], v[132:147]
    ds_read_b128 v[124:127], v219 offset:352
    s_add_u32 m0, s97, 33792
    s_add_u32 s67, s71, 26624
    buffer_load_dwordx4 v8, s[36:39], s67 offen  lds
    ds_read_b128 v[128:131], v219 offset:21584
    v_mul_f32 v100, v44, v48
    v_mul_f32 v101, v44, v49
    v_mul_f32 v102, v44, v50
    s_add_u32 m0, s97, 34816
    s_add_u32 s67, s71, 53248
    buffer_load_dwordx4 v9, s[36:39], s67 offen  lds
    v_mul_f32 v103, v44, v51
    v_mfma_f32_32x32x16_bf16 v[164:179], v[116:119], v[88:91], v[164:179]
    v_cvt_pk_bf16_f32 v92, v100, v101
    v_mul_f32 v104, v44, v52
    s_add_u32 m0, s97, 35840
    s_add_u32 s67, s71, 79872
    buffer_load_dwordx4 v9, s[36:39], s67 offen  lds
    v_mul_f32 v105, v44, v53
    v_cvt_pk_bf16_f32 v93, v102, v103
    v_mul_f32 v106, v44, v54
    v_mul_f32 v107, v44, v55
    s_mov_b32 s67, s7
    s_add_u32 m0, s96, 32768
    s_nop 0
    buffer_load_dwordx4 v28, s[32:35], s67 offen  lds
    v_cvt_pk_bf16_f32 v94, v104, v105
    v_mfma_f32_32x32x16_bf16 v[148:163], v[120:123], v[84:87], v[148:163]
    v_cvt_pk_bf16_f32 v95, v106, v107
    v_mul_f32 v108, v70, v74
    s_add_u32 m0, s96, 33792
    s_nop 0
    buffer_load_dwordx4 v29, s[32:35], s67 offen  lds
    v_mul_f32 v109, v70, v75
    v_mul_f32 v110, v70, v76
    v_mul_f32 v111, v70, v77
    v_cvt_pk_bf16_f32 v96, v108, v109
    s_add_u32 m0, s96, 34816
    s_nop 0
    buffer_load_dwordx4 v30, s[32:35], s67 offen  lds
    v_mfma_f32_32x32x16_bf16 v[180:195], v[120:123], v[88:91], v[180:195]
    v_mul_f32 v112, v70, v78
    v_mul_f32 v113, v70, v79
    v_cvt_pk_bf16_f32 v97, v110, v111
    s_add_u32 m0, s96, 35840
    s_nop 0
    buffer_load_dwordx4 v31, s[32:35], s67 offen  lds
    v_mul_f32 v114, v70, v80
    v_mul_f32 v115, v70, v81
    v_cvt_pk_bf16_f32 v98, v112, v113
    v_cvt_pk_bf16_f32 v99, v114, v115
    s_waitcnt vmcnt(8)
    s_barrier
    s_add_u32 s27, s70, 4
    s_and_b32 s27, s27, 3
    s_add_u32 s27, s27, 16
    s_mul_i32 s71, s27, 851968
    s_add_u32 s71, s71, s98
    s_add_u32 m0, s97, 65536
    s_add_u32 s67, s71, 0
    buffer_load_dwordx4 v8, s[36:39], s67 offen  lds
    s_nop 0
    s_waitcnt lgkmcnt(0)
    v_mfma_f32_32x32x16_bf16 v[132:147], v[124:127], v[92:95], v[132:147]
    ds_read_b128 v[116:119], v219 offset:384
    s_add_u32 m0, s97, 66560
    s_add_u32 s67, s71, 26624
    buffer_load_dwordx4 v8, s[36:39], s67 offen  lds
    ds_read_b128 v[120:123], v219 offset:21616
    v_mul_f32 v100, v44, v56
    v_mul_f32 v101, v44, v57
    v_mul_f32 v102, v46, v46
    s_add_u32 m0, s97, 67584
    s_add_u32 s67, s71, 53248
    buffer_load_dwordx4 v9, s[36:39], s67 offen  lds
    v_mul_f32 v103, v46, v47
    v_mfma_f32_32x32x16_bf16 v[164:179], v[124:127], v[96:99], v[164:179]
    v_cvt_pk_bf16_f32 v84, v100, v101
    v_mul_f32 v104, v46, v48
    s_add_u32 m0, s97, 68608
    s_add_u32 s67, s71, 79872
    buffer_load_dwordx4 v9, s[36:39], s67 offen  lds
    v_mul_f32 v105, v46, v49
    v_cvt_pk_bf16_f32 v85, v102, v103
    v_mul_f32 v106, v46, v50
    v_mul_f32 v107, v46, v51
    s_waitcnt lgkmcnt(0)
    v_lshl_add_u32 v16, v16, 8, v4
    v_lshl_add_u32 v17, v17, 8, v5
    v_lshl_add_u32 v18, v18, 8, v4
    v_lshl_add_u32 v19, v19, 8, v5
    s_mov_b32 s67, s6
    s_add_u32 m0, s96, 65536
    s_nop 0
    buffer_load_dwordx4 v16, s[32:35], s67 offen  lds
    v_cvt_pk_bf16_f32 v86, v104, v105
    v_mfma_f32_32x32x16_bf16 v[148:163], v[128:131], v[92:95], v[148:163]
    v_cvt_pk_bf16_f32 v87, v106, v107
    v_mul_f32 v108, v70, v82
    s_add_u32 m0, s96, 66560
    s_nop 0
    buffer_load_dwordx4 v17, s[32:35], s67 offen  lds
    v_mul_f32 v109, v70, v83
    v_mul_f32 v110, v72, v72
    v_mul_f32 v111, v72, v73
    v_cvt_pk_bf16_f32 v88, v108, v109
    s_add_u32 m0, s96, 67584
    s_nop 0
    buffer_load_dwordx4 v18, s[32:35], s67 offen  lds
    v_mfma_f32_32x32x16_bf16 v[180:195], v[128:131], v[96:99], v[180:195]
    v_mul_f32 v112, v72, v74
    v_mul_f32 v113, v72, v75
    v_cvt_pk_bf16_f32 v89, v110, v111
    s_add_u32 m0, s96, 68608
    s_nop 0
    buffer_load_dwordx4 v19, s[32:35], s67 offen  lds
    v_mul_f32 v114, v72, v76
    v_mul_f32 v115, v72, v77
    v_cvt_pk_bf16_f32 v90, v112, v113
    v_cvt_pk_bf16_f32 v91, v114, v115
    s_add_u32 s26, s70, 5
    s_and_b32 s26, s26, 3
    s_add_u32 s26, s26, 16
    s_lshl_b32 s26, s26, 2
    v_add_u32 v7, s26, v10
    ds_read_b32 v20, v7 offset:0
    ds_read_b32 v21, v7 offset:832
    ds_read_b32 v22, v7 offset:1664
    ds_read_b32 v23, v7 offset:2496
    s_waitcnt vmcnt(8)
    s_barrier
    s_add_u32 s71, s71, s5
    s_add_u32 m0, s97, 0
    s_add_u32 s67, s71, 0
    buffer_load_dwordx4 v8, s[36:39], s67 offen  lds
    s_add_u32 m0, s97, 1024
    s_add_u32 s67, s71, 26624
    buffer_load_dwordx4 v8, s[36:39], s67 offen  lds
    s_add_u32 m0, s97, 2048
    s_add_u32 s67, s71, 53248
    buffer_load_dwordx4 v9, s[36:39], s67 offen  lds
    s_add_u32 m0, s97, 3072
    s_add_u32 s67, s71, 79872
    buffer_load_dwordx4 v9, s[36:39], s67 offen  lds
    s_mov_b32 s67, s7
    s_add_u32 m0, s96, 0
    s_nop 0
    buffer_load_dwordx4 v16, s[32:35], s67 offen  lds
    s_add_u32 m0, s96, 1024
    s_nop 0
    buffer_load_dwordx4 v17, s[32:35], s67 offen  lds
    s_add_u32 m0, s96, 2048
    s_nop 0
    buffer_load_dwordx4 v18, s[32:35], s67 offen  lds
    s_add_u32 m0, s96, 3072
    s_nop 0
    buffer_load_dwordx4 v19, s[32:35], s67 offen  lds
    s_waitcnt vmcnt(8)
    s_barrier
    s_add_u32 s27, s70, 5
    s_and_b32 s27, s27, 3
    s_add_u32 s27, s27, 16
    s_mul_i32 s71, s27, 851968
    s_add_u32 s71, s71, s98
    s_add_u32 m0, s97, 32768
    s_add_u32 s67, s71, 0
    buffer_load_dwordx4 v8, s[36:39], s67 offen  lds
    s_nop 0
    s_waitcnt lgkmcnt(0)
    v_mfma_f32_32x32x16_bf16 v[132:147], v[116:119], v[84:87], v[132:147]
    ds_read_b128 v[124:127], v219 offset:416
    s_add_u32 m0, s97, 33792
    s_add_u32 s67, s71, 26624
    buffer_load_dwordx4 v8, s[36:39], s67 offen  lds
    ds_read_b128 v[128:131], v219 offset:21648
    v_mul_f32 v100, v46, v52
    v_mul_f32 v101, v46, v53
    v_mul_f32 v102, v46, v54
    s_add_u32 m0, s97, 34816
    s_add_u32 s67, s71, 53248
    buffer_load_dwordx4 v9, s[36:39], s67 offen  lds
    v_mul_f32 v103, v46, v55
    v_mfma_f32_32x32x16_bf16 v[164:179], v[116:119], v[88:91], v[164:179]
    v_cvt_pk_bf16_f32 v92, v100, v101
    v_mul_f32 v104, v46, v56
    s_add_u32 m0, s97, 35840
    s_add_u32 s67, s71, 79872
    buffer_load_dwordx4 v9, s[36:39], s67 offen  lds
    v_mul_f32 v105, v46, v57
    v_cvt_pk_bf16_f32 v93, v102, v103
    v_mul_f32 v106, v46, v32
    v_mul_f32 v107, v48, v48
    s_waitcnt lgkmcnt(0)
    v_lshl_add_u32 v20, v20, 8, v4
    v_lshl_add_u32 v21, v21, 8, v5
    v_lshl_add_u32 v22, v22, 8, v4
    v_lshl_add_u32 v23, v23, 8, v5
    s_mov_b32 s67, s6
    s_add_u32 m0, s96, 32768
    s_nop 0
    buffer_load_dwordx4 v20, s[32:35], s67 offen  lds
    v_cvt_pk_bf16_f32 v94, v104, v105
    v_mfma_f32_32x32x16_bf16 v[148:163], v[120:123], v[84:87], v[148:163]
    v_cvt_pk_bf16_f32 v95, v106, v107
    v_mul_f32 v108, v72, v78
    s_add_u32 m0, s96, 33792
    s_nop 0
    buffer_load_dwordx4 v21, s[32:35], s67 offen  lds
    v_mul_f32 v109, v72, v79
    v_mul_f32 v110, v72, v80
    v_mul_f32 v111, v72, v81
    v_cvt_pk_bf16_f32 v96, v108, v109
    s_add_u32 m0, s96, 34816
    s_nop 0
    buffer_load_dwordx4 v22, s[32:35], s67 offen  lds
    v_mfma_f32_32x32x16_bf16 v[180:195], v[120:123], v[88:91], v[180:195]
    v_mul_f32 v112, v72, v82
    v_mul_f32 v113, v72, v83
    v_cvt_pk_bf16_f32 v97, v110, v111
    s_add_u32 m0, s96, 35840
    s_nop 0
    buffer_load_dwordx4 v23, s[32:35], s67 offen  lds
    v_mul_f32 v114, v72, v58
    v_mul_f32 v115, v74, v74
    v_cvt_pk_bf16_f32 v98, v112, v113
    v_cvt_pk_bf16_f32 v99, v114, v115
    s_add_u32 s26, s70, 6
    s_and_b32 s26, s26, 3
    s_add_u32 s26, s26, 16
    s_lshl_b32 s26, s26, 2
    v_add_u32 v7, s26, v10
    ds_read_b32 v24, v7 offset:0
    ds_read_b32 v25, v7 offset:832
    ds_read_b32 v26, v7 offset:1664
    ds_read_b32 v27, v7 offset:2496
    s_waitcnt vmcnt(8)
    s_barrier
    s_add_u32 s71, s71, s5
    s_add_u32 m0, s97, 65536
    s_add_u32 s67, s71, 0
    buffer_load_dwordx4 v8, s[36:39], s67 offen  lds
    s_nop 0
    s_waitcnt lgkmcnt(0)
    v_mfma_f32_32x32x16_bf16 v[132:147], v[124:127], v[92:95], v[132:147]
    ds_read_b128 v[116:119], v219 offset:448
    s_add_u32 m0, s97, 66560
    s_add_u32 s67, s71, 26624
    buffer_load_dwordx4 v8, s[36:39], s67 offen  lds
    ds_read_b128 v[120:123], v219 offset:21680
    v_mul_f32 v100, v48, v49
    v_mul_f32 v101, v48, v50
    v_mul_f32 v102, v48, v51
    s_add_u32 m0, s97, 67584
    s_add_u32 s67, s71, 53248
    buffer_load_dwordx4 v9, s[36:39], s67 offen  lds
    v_mul_f32 v103, v48, v52
    v_mfma_f32_32x32x16_bf16 v[164:179], v[124:127], v[96:99], v[164:179]
    v_cvt_pk_bf16_f32 v84, v100, v101
    v_mul_f32 v104, v48, v53
    s_add_u32 m0, s97, 68608
    s_add_u32 s67, s71, 79872
    buffer_load_dwordx4 v9, s[36:39], s67 offen  lds
    v_mul_f32 v105, v48, v54
    v_cvt_pk_bf16_f32 v85, v102, v103
    v_mul_f32 v106, v48, v55
    v_mul_f32 v107, v48, v56
    s_mov_b32 s67, s7
    s_add_u32 m0, s96, 65536
    s_nop 0
    buffer_load_dwordx4 v20, s[32:35], s67 offen  lds
    v_cvt_pk_bf16_f32 v86, v104, v105
    v_mfma_f32_32x32x16_bf16 v[148:163], v[128:131], v[92:95], v[148:163]
    v_cvt_pk_bf16_f32 v87, v106, v107
    v_mul_f32 v108, v74, v75
    s_add_u32 m0, s96, 66560
    s_nop 0
    buffer_load_dwordx4 v21, s[32:35], s67 offen  lds
    v_mul_f32 v109, v74, v76
    v_mul_f32 v110, v74, v77
    v_mul_f32 v111, v74, v78
    v_cvt_pk_bf16_f32 v88, v108, v109
    s_add_u32 m0, s96, 67584
    s_nop 0
    buffer_load_dwordx4 v22, s[32:35], s67 offen  lds
    v_mfma_f32_32x32x16_bf16 v[180:195], v[128:131], v[96:99], v[180:195]
    v_mul_f32 v112, v74, v79
    v_mul_f32 v113, v74, v80
    v_cvt_pk_bf16_f32 v89, v110, v111
    s_add_u32 m0, s96, 68608
    s_nop 0
    buffer_load_dwordx4 v23, s[32:35], s67 offen  lds
    v_mul_f32 v114, v74, v81
    v_mul_f32 v115, v74, v82
    v_cvt_pk_bf16_f32 v90, v112, v113
    v_cvt_pk_bf16_f32 v91, v114, v115
    s_waitcnt vmcnt(8)
    s_barrier
    s_add_u32 s27, s70, 6
    s_and_b32 s27, s27, 3
    s_add_u32 s27, s27, 16
    s_mul_i32 s71, s27, 851968
    s_add_u32 s71, s71, s98
    s_add_u32 m0, s97, 0
    s_add_u32 s67, s71, 0
    buffer_load_dwordx4 v8, s[36:39], s67 offen  lds
    s_nop 0
    s_waitcnt lgkmcnt(0)
    v_mfma_f32_32x32x16_bf16 v[132:147], v[116:119], v[84:87], v[132:147]
    ds_read_b128 v[124:127], v219 offset:480
    s_add_u32 m0, s97, 1024
    s_add_u32 s67, s71, 26624
    buffer_load_dwordx4 v8, s[36:39], s67 offen  lds
    ds_read_b128 v[128:131], v219 offset:21712
    v_mul_f32 v100, v48, v57
    v_mul_f32 v101, v48, v32
    v_mul_f32 v102, v48, v33
    s_add_u32 m0, s97, 2048
    s_add_u32 s67, s71, 53248
    buffer_load_dwordx4 v9, s[36:39], s67 offen  lds
    v_mul_f32 v103, v48, v34
    v_mfma_f32_32x32x16_bf16 v[164:179], v[116:119], v[88:91], v[164:179]
    v_cvt_pk_bf16_f32 v92, v100, v101
    v_mul_f32 v104, v50, v50
    s_add_u32 m0, s97, 3072
    s_add_u32 s67, s71, 79872
    buffer_load_dwordx4 v9, s[36:39], s67 offen  lds
    v_mul_f32 v105, v50, v51
    v_cvt_pk_bf16_f32 v93, v102, v103
    v_mul_f32 v106, v50, v52
    v_mul_f32 v107, v50, v53
    s_waitcnt lgkmcnt(0)
    v_lshl_add_u32 v24, v24, 8, v4
    v_lshl_add_u32 v25, v25, 8, v5
    v_lshl_add_u32 v26, v26, 8, v4
    v_lshl_add_u32 v27, v27, 8, v5
    s_mov_b32 s67, s6
    s_add_u32 m0, s96, 0
    s_nop 0
    buffer_load_dwordx4 v24, s[32:35], s67 offen  lds
    v_cvt_pk_bf16_f32 v94, v104, v105
    v_mfma_f32_32x32x16_bf16 v[148:163], v[120:123], v[84:87], v[148:163]
    v_cvt_pk_bf16_f32 v95, v106, v107
    v_mul_f32 v108, v74, v83
    s_add_u32 m0, s96, 1024
    s_nop 0
    buffer_load_dwordx4 v25, s[32:35], s67 offen  lds
    v_mul_f32 v109, v74, v58
    v_mul_f32 v110, v74, v59
    v_mul_f32 v111, v74, v60
    v_cvt_pk_bf16_f32 v96, v108, v109
    s_add_u32 m0, s96, 2048
    s_nop 0
    buffer_load_dwordx4 v26, s[32:35], s67 offen  lds
    v_mfma_f32_32x32x16_bf16 v[180:195], v[120:123], v[88:91], v[180:195]
    v_mul_f32 v112, v76, v76
    v_mul_f32 v113, v76, v77
    v_cvt_pk_bf16_f32 v97, v110, v111
    s_add_u32 m0, s96, 3072
    s_nop 0
    buffer_load_dwordx4 v27, s[32:35], s67 offen  lds
    v_mul_f32 v114, v76, v78
    v_mul_f32 v115, v76, v79
    v_cvt_pk_bf16_f32 v98, v112, v113
    v_cvt_pk_bf16_f32 v99, v114, v115
    s_add_u32 s26, s70, 7
    s_and_b32 s26, s26, 3
    s_add_u32 s26, s26, 16
    s_lshl_b32 s26, s26, 2
    v_add_u32 v7, s26, v10
    ds_read_b32 v28, v7 offset:0
    ds_read_b32 v29, v7 offset:832
    ds_read_b32 v30, v7 offset:1664
    ds_read_b32 v31, v7 offset:2496
    s_waitcnt vmcnt(8)
    s_barrier
    s_add_u32 s71, s71, s5
    s_add_u32 m0, s97, 32768
    s_add_u32 s67, s71, 0
    buffer_load_dwordx4 v8, s[36:39], s67 offen  lds
    s_nop 0
    s_waitcnt lgkmcnt(0)
    v_mfma_f32_32x32x16_bf16 v[132:147], v[124:127], v[92:95], v[132:147]
    ds_read_b128 v[116:119], v219 offset:512
    s_add_u32 m0, s97, 33792
    s_add_u32 s67, s71, 26624
    buffer_load_dwordx4 v8, s[36:39], s67 offen  lds
    ds_read_b128 v[120:123], v219 offset:21744
    v_mul_f32 v100, v50, v54
    v_mul_f32 v101, v50, v55
    v_mul_f32 v102, v50, v56
    s_add_u32 m0, s97, 34816
    s_add_u32 s67, s71, 53248
    buffer_load_dwordx4 v9, s[36:39], s67 offen  lds
    v_mul_f32 v103, v50, v57
    v_mfma_f32_32x32x16_bf16 v[164:179], v[124:127], v[96:99], v[164:179]
    v_cvt_pk_bf16_f32 v84, v100, v101
    v_mul_f32 v104, v50, v32
    s_add_u32 m0, s97, 35840
    s_add_u32 s67, s71, 79872
    buffer_load_dwordx4 v9, s[36:39], s67 offen  lds
    v_mul_f32 v105, v50, v33
    v_cvt_pk_bf16_f32 v85, v102, v103
    v_mul_f32 v106, v50, v34
    v_mul_f32 v107, v50, v35
    s_mov_b32 s67, s7
    s_add_u32 m0, s96, 32768
    s_nop 0
    buffer_load_dwordx4 v24, s[32:35], s67 offen  lds
    v_cvt_pk_bf16_f32 v86, v104, v105
    v_mfma_f32_32x32x16_bf16 v[148:163], v[128:131], v[92:95], v[148:163]
    v_cvt_pk_bf16_f32 v87, v106, v107
    v_mul_f32 v108, v76, v80
    s_add_u32 m0, s96, 33792
    s_nop 0
    buffer_load_dwordx4 v25, s[32:35], s67 offen  lds
    v_mul_f32 v109, v76, v81
    v_mul_f32 v110, v76, v82
    v_mul_f32 v111, v76, v83
    v_cvt_pk_bf16_f32 v88, v108, v109
    s_add_u32 m0, s96, 34816
    s_nop 0
    buffer_load_dwordx4 v26, s[32:35], s67 offen  lds
    v_mfma_f32_32x32x16_bf16 v[180:195], v[128:131], v[96:99], v[180:195]
    v_mul_f32 v112, v76, v58
    v_mul_f32 v113, v76, v59
    v_cvt_pk_bf16_f32 v89, v110, v111
    s_add_u32 m0, s96, 35840
    s_nop 0
    buffer_load_dwordx4 v27, s[32:35], s67 offen  lds
    v_mul_f32 v114, v76, v60
    v_mul_f32 v115, v76, v61
    v_cvt_pk_bf16_f32 v90, v112, v113
    v_cvt_pk_bf16_f32 v91, v114, v115
    s_waitcnt vmcnt(8)
    s_barrier
    s_add_u32 s27, s70, 7
    s_and_b32 s27, s27, 3
    s_add_u32 s27, s27, 16
    s_mul_i32 s71, s27, 851968
    s_add_u32 s71, s71, s98
    s_add_u32 m0, s97, 65536
    s_add_u32 s67, s71, 0
    buffer_load_dwordx4 v8, s[36:39], s67 offen  lds
    s_add_u32 m0, s97, 66560
    s_add_u32 s67, s71, 26624
    buffer_load_dwordx4 v8, s[36:39], s67 offen  lds
    s_add_u32 m0, s97, 67584
    s_add_u32 s67, s71, 53248
    buffer_load_dwordx4 v9, s[36:39], s67 offen  lds
    s_add_u32 m0, s97, 68608
    s_add_u32 s67, s71, 79872
    buffer_load_dwordx4 v9, s[36:39], s67 offen  lds
    s_waitcnt lgkmcnt(0)
    v_lshl_add_u32 v28, v28, 8, v4
    v_lshl_add_u32 v29, v29, 8, v5
    v_lshl_add_u32 v30, v30, 8, v4
    v_lshl_add_u32 v31, v31, 8, v5
    s_mov_b32 s67, s6
    s_add_u32 m0, s96, 65536
    s_nop 0
    buffer_load_dwordx4 v28, s[32:35], s67 offen  lds
    s_add_u32 m0, s96, 66560
    s_nop 0
    buffer_load_dwordx4 v29, s[32:35], s67 offen  lds
    s_add_u32 m0, s96, 67584
    s_nop 0
    buffer_load_dwordx4 v30, s[32:35], s67 offen  lds
    s_add_u32 m0, s96, 68608
    s_nop 0
    buffer_load_dwordx4 v31, s[32:35], s67 offen  lds
    s_add_u32 s26, s70, 5
    s_and_b32 s26, s26, 3
    s_add_u32 s26, s26, 20
    s_lshl_b32 s26, s26, 2
    v_add_u32 v7, s26, v10
    ds_read_b32 v16, v7 offset:0
    ds_read_b32 v17, v7 offset:832
    ds_read_b32 v18, v7 offset:1664
    ds_read_b32 v19, v7 offset:2496
    s_waitcnt vmcnt(8)
    s_barrier
    s_add_u32 s71, s71, s5
    s_add_u32 m0, s97, 0
    s_add_u32 s67, s71, 0
    buffer_load_dwordx4 v8, s[36:39], s67 offen  lds
    s_nop 0
    s_waitcnt lgkmcnt(0)
    v_mfma_f32_32x32x16_bf16 v[132:147], v[116:119], v[84:87], v[132:147]
    ds_read_b128 v[124:127], v219 offset:544
    s_add_u32 m0, s97, 1024
    s_add_u32 s67, s71, 26624
    buffer_load_dwordx4 v8, s[36:39], s67 offen  lds
    ds_read_b128 v[128:131], v219 offset:21776
    v_mul_f32 v100, v50, v36
    v_mul_f32 v101, v52, v52
    v_mul_f32 v102, v52, v53
    s_add_u32 m0, s97, 2048
    s_add_u32 s67, s71, 53248
    buffer_load_dwordx4 v9, s[36:39], s67 offen  lds
    v_mul_f32 v103, v52, v54
    v_mfma_f32_32x32x16_bf16 v[164:179], v[116:119], v[88:91], v[164:179]
    v_cvt_pk_bf16_f32 v92, v100, v101
    v_mul_f32 v104, v52, v55
    s_add_u32 m0, s97, 3072
    s_add_u32 s67, s71, 79872
    buffer_load_dwordx4 v9, s[36:39], s67 offen  lds
    v_mul_f32 v105, v52, v56
    v_cvt_pk_bf16_f32 v93, v102, v103
    v_mul_f32 v106, v52, v57
    v_mul_f32 v107, v52, v32
    s_mov_b32 s67, s7
    s_add_u32 m0, s96, 0
    s_nop 0
    buffer_load_dwordx4 v28, s[32:35], s67 offen  lds
    v_cvt_pk_bf16_f32 v94, v104, v105
    v_mfma_f32_32x32x16_bf16 v[148:163], v[120:123], v[84:87], v[148:163]
    v_cvt_pk_bf16_f32 v95, v106, v107
    v_mul_f32 v108, v76, v62
    s_add_u32 m0, s96, 1024
    s_nop 0
    buffer_load_dwordx4 v29, s[32:35], s67 offen  lds
    v_mul_f32 v109, v78, v78
    v_mul_f32 v110, v78, v79
    v_mul_f32 v111, v78, v80
    v_cvt_pk_bf16_f32 v96, v108, v109
    s_add_u32 m0, s96, 2048
    s_nop 0
    buffer_load_dwordx4 v30, s[32:35], s67 offen  lds
    v_mfma_f32_32x32x16_bf16 v[180:195], v[120:123], v[88:91], v[180:195]
    v_mul_f32 v112, v78, v81
    v_mul_f32 v113, v78, v82
    v_cvt_pk_bf16_f32 v97, v110, v111
    s_add_u32 m0, s96, 3072
    s_nop 0
    buffer_load_dwordx4 v31, s[32:35], s67 offen  lds
    v_mul_f32 v114, v78, v83
    v_mul_f32 v115, v78, v58
    v_cvt_pk_bf16_f32 v98, v112, v113
    v_cvt_pk_bf16_f32 v99, v114, v115
    s_waitcnt vmcnt(8)
    s_barrier
    s_add_u32 s27, s70, 5
    s_and_b32 s27, s27, 3
    s_add_u32 s27, s27, 20
    s_mul_i32 s71, s27, 851968
    s_add_u32 s71, s71, s98
    s_add_u32 m0, s97, 32768
    s_add_u32 s67, s71, 0
    buffer_load_dwordx4 v8, s[36:39], s67 offen  lds
    s_nop 0
    s_waitcnt lgkmcnt(0)
    v_mfma_f32_32x32x16_bf16 v[132:147], v[124:127], v[92:95], v[132:147]
    ds_read_b128 v[116:119], v219 offset:576
    s_add_u32 m0, s97, 33792
    s_add_u32 s67, s71, 26624
    buffer_load_dwordx4 v8, s[36:39], s67 offen  lds
    ds_read_b128 v[120:123], v219 offset:21808
    v_mul_f32 v100, v52, v33
    v_mul_f32 v101, v52, v34
    v_mul_f32 v102, v52, v35
    s_add_u32 m0, s97, 34816
    s_add_u32 s67, s71, 53248
    buffer_load_dwordx4 v9, s[36:39], s67 offen  lds
    v_mul_f32 v103, v52, v36
    v_mfma_f32_32x32x16_bf16 v[164:179], v[124:127], v[96:99], v[164:179]
    v_cvt_pk_bf16_f32 v84, v100, v101
    v_mul_f32 v104, v52, v37
    s_add_u32 m0, s97, 35840
    s_add_u32 s67, s71, 79872
    buffer_load_dwordx4 v9, s[36:39], s67 offen  lds
    v_mul_f32 v105, v52, v38
    v_cvt_pk_bf16_f32 v85, v102, v103
    v_mul_f32 v106, v54, v54
    v_mul_f32 v107, v54, v55
    s_waitcnt lgkmcnt(0)
    v_lshl_add_u32 v16, v16, 8, v4
    v_lshl_add_u32 v17, v17, 8, v5
    v_lshl_add_u32 v18, v18, 8, v4
    v_lshl_add_u32 v19, v19, 8, v5
    s_mov_b32 s67, s6
    s_add_u32 m0, s96, 32768
    s_nop 0
    buffer_load_dwordx4 v16, s[32:35], s67 offen  lds
    v_cvt_pk_bf16_f32 v86, v104, v105
    v_mfma_f32_32x32x16_bf16 v[148:163], v[128:131], v[92:95], v[148:163]
    v_cvt_pk_bf16_f32 v87, v106, v107
    v_mul_f32 v108, v78, v59
    s_add_u32 m0, s96, 33792
    s_nop 0
    buffer_load_dwordx4 v17, s[32:35], s67 offen  lds
    v_mul_f32 v109, v78, v60
    v_mul_f32 v110, v78, v61
    v_mul_f32 v111, v78, v62
    v_cvt_pk_bf16_f32 v88, v108, v109
    s_add_u32 m0, s96, 34816
    s_nop 0
    buffer_load_dwordx4 v18, s[32:35], s67 offen  lds
    v_mfma_f32_32x32x16_bf16 v[180:195], v[128:131], v[96:99], v[180:195]
    v_mul_f32 v112, v78, v63
    v_mul_f32 v113, v78, v64
    v_cvt_pk_bf16_f32 v89, v110, v111
    s_add_u32 m0, s96, 35840
    s_nop 0
    buffer_load_dwordx4 v19, s[32:35], s67 offen  lds
    v_mul_f32 v114, v80, v80
    v_mul_f32 v115, v80, v81
    v_cvt_pk_bf16_f32 v90, v112, v113
    v_cvt_pk_bf16_f32 v91, v114, v115
    s_add_u32 s26, s70, 6
    s_and_b32 s26, s26, 3
    s_add_u32 s26, s26, 20
    s_lshl_b32 s26, s26, 2
    v_add_u32 v7, s26, v10
    ds_read_b32 v20, v7 offset:0
    ds_read_b32 v21, v7 offset:832
    ds_read_b32 v22, v7 offset:1664
    ds_read_b32 v23, v7 offset:2496
    s_waitcnt vmcnt(8)
    s_barrier
    s_add_u32 s71, s71, s5
    s_add_u32 m0, s97, 65536
    s_add_u32 s67, s71, 0
    buffer_load_dwordx4 v8, s[36:39], s67 offen  lds
    s_nop 0
    s_waitcnt lgkmcnt(0)
    v_mfma_f32_32x32x16_bf16 v[132:147], v[116:119], v[84:87], v[132:147]
    ds_read_b128 v[124:127], v219 offset:608
    s_add_u32 m0, s97, 66560
    s_add_u32 s67, s71, 26624
    buffer_load_dwordx4 v8, s[36:39], s67 offen  lds
    ds_read_b128 v[128:131], v219 offset:21840
    v_mul_f32 v100, v54, v56
    v_mul_f32 v101, v54, v57
    v_mul_f32 v102, v54, v32
    s_add_u32 m0, s97, 67584
    s_add_u32 s67, s71, 53248
    buffer_load_dwordx4 v9, s[36:39], s67 offen  lds
    v_mul_f32 v103, v54, v33
    v_mfma_f32_32x32x16_bf16 v[164:179], v[116:119], v[88:91], v[164:179]
    v_cvt_pk_bf16_f32 v92, v100, v101
    v_mul_f32 v104, v54, v34
    s_add_u32 m0, s97, 68608
    s_add_u32 s67, s71, 79872
    buffer_load_dwordx4 v9, s[36:39], s67 offen  lds
    v_mul_f32 v105, v54, v35
    v_cvt_pk_bf16_f32 v93, v102, v103
    v_mul_f32 v106, v54, v36
    v_mul_f32 v107, v54, v37
    s_mov_b32 s67, s7
    s_add_u32 m0, s96, 65536
    s_nop 0
    buffer_load_dwordx4 v16, s[32:35], s67 offen  lds
    v_cvt_pk_bf16_f32 v94, v104, v105
    v_mfma_f32_32x32x16_bf16 v[148:163], v[120:123], v[84:87], v[148:163]
    v_cvt_pk_bf16_f32 v95, v106, v107
    v_mul_f32 v108, v80, v82
    s_add_u32 m0, s96, 66560
    s_nop 0
    buffer_load_dwordx4 v17, s[32:35], s67 offen  lds
    v_mul_f32 v109, v80, v83
    v_mul_f32 v110, v80, v58
    v_mul_f32 v111, v80, v59
    v_cvt_pk_bf16_f32 v96, v108, v109
    s_add_u32 m0, s96, 67584
    s_nop 0
    buffer_load_dwordx4 v18, s[32:35], s67 offen  lds
    v_mfma_f32_32x32x16_bf16 v[180:195], v[120:123], v[88:91], v[180:195]
    v_mul_f32 v112, v80, v60
    v_mul_f32 v113, v80, v61
    v_cvt_pk_bf16_f32 v97, v110, v111
    s_add_u32 m0, s96, 68608
    s_nop 0
    buffer_load_dwordx4 v19, s[32:35], s67 offen  lds
    v_mul_f32 v114, v80, v62
    v_mul_f32 v115, v80, v63
    v_cvt_pk_bf16_f32 v98, v112, v113
    v_cvt_pk_bf16_f32 v99, v114, v115
    s_waitcnt vmcnt(8)
    s_barrier
    s_add_u32 s27, s70, 6
    s_and_b32 s27, s27, 3
    s_add_u32 s27, s27, 20
    s_mul_i32 s71, s27, 851968
    s_add_u32 s71, s71, s98
    s_add_u32 m0, s97, 0
    s_add_u32 s67, s71, 0
    buffer_load_dwordx4 v8, s[36:39], s67 offen  lds
    s_nop 0
    s_waitcnt lgkmcnt(0)
    v_mfma_f32_32x32x16_bf16 v[132:147], v[124:127], v[92:95], v[132:147]
    ds_read_b128 v[116:119], v219 offset:640
    s_add_u32 m0, s97, 1024
    s_add_u32 s67, s71, 26624
    buffer_load_dwordx4 v8, s[36:39], s67 offen  lds
    ds_read_b128 v[120:123], v219 offset:21872
    v_mul_f32 v100, v54, v38
    v_mul_f32 v101, v54, v39
    v_mul_f32 v102, v54, v40
    s_add_u32 m0, s97, 2048
    s_add_u32 s67, s71, 53248
    buffer_load_dwordx4 v9, s[36:39], s67 offen  lds
    v_mul_f32 v103, v56, v56
    v_mfma_f32_32x32x16_bf16 v[164:179], v[124:127], v[96:99], v[164:179]
    v_cvt_pk_bf16_f32 v84, v100, v101
    v_mul_f32 v104, v56, v57
    s_add_u32 m0, s97, 3072
    s_add_u32 s67, s71, 79872
    buffer_load_dwordx4 v9, s[36:39], s67 offen  lds
    v_mul_f32 v105, v56, v32
    v_cvt_pk_bf16_f32 v85, v102, v103
    v_mul_f32 v106, v56, v33
    v_mul_f32 v107, v56, v34
    s_waitcnt lgkmcnt(0)
    v_lshl_add_u32 v20, v20, 8, v4
    v_lshl_add_u32 v21, v21, 8, v5
    v_lshl_add_u32 v22, v22, 8, v4
    v_lshl_add_u32 v23, v23, 8, v5
    s_mov_b32 s67, s6
    s_add_u32 m0, s96, 0
    s_nop 0
    buffer_load_dwordx4 v20, s[32:35], s67 offen  lds
    v_cvt_pk_bf16_f32 v86, v104, v105
    v_mfma_f32_32x32x16_bf16 v[148:163], v[128:131], v[92:95], v[148:163]
    v_cvt_pk_bf16_f32 v87, v106, v107
    v_mul_f32 v108, v80, v64
    s_add_u32 m0, s96, 1024
    s_nop 0
    buffer_load_dwordx4 v21, s[32:35], s67 offen  lds
    v_mul_f32 v109, v80, v65
    v_mul_f32 v110, v80, v66
    v_mul_f32 v111, v82, v82
    v_cvt_pk_bf16_f32 v88, v108, v109
    s_add_u32 m0, s96, 2048
    s_nop 0
    buffer_load_dwordx4 v22, s[32:35], s67 offen  lds
    v_mfma_f32_32x32x16_bf16 v[180:195], v[128:131], v[96:99], v[180:195]
    v_mul_f32 v112, v82, v83
    v_mul_f32 v113, v82, v58
    v_cvt_pk_bf16_f32 v89, v110, v111
    s_add_u32 m0, s96, 3072
    s_nop 0
    buffer_load_dwordx4 v23, s[32:35], s67 offen  lds
    v_mul_f32 v114, v82, v59
    v_mul_f32 v115, v82, v60
    v_cvt_pk_bf16_f32 v90, v112, v113
    v_cvt_pk_bf16_f32 v91, v114, v115
    s_add_u32 s26, s70, 7
    s_and_b32 s26, s26, 3
    s_add_u32 s26, s26, 20
    s_lshl_b32 s26, s26, 2
    v_add_u32 v7, s26, v10
    ds_read_b32 v24, v7 offset:0
    ds_read_b32 v25, v7 offset:832
    ds_read_b32 v26, v7 offset:1664
    ds_read_b32 v27, v7 offset:2496
    s_waitcnt vmcnt(8)
    s_barrier
    s_add_u32 s71, s71, s5
    s_add_u32 m0, s97, 32768
    s_add_u32 s67, s71, 0
    buffer_load_dwordx4 v8, s[36:39], s67 offen  lds
    s_add_u32 m0, s97, 33792
    s_add_u32 s67, s71, 26624
    buffer_load_dwordx4 v8, s[36:39], s67 offen  lds
    s_add_u32 m0, s97, 34816
    s_add_u32 s67, s71, 53248
    buffer_load_dwordx4 v9, s[36:39], s67 offen  lds
    s_add_u32 m0, s97, 35840
    s_add_u32 s67, s71, 79872
    buffer_load_dwordx4 v9, s[36:39], s67 offen  lds
    s_mov_b32 s67, s7
    s_add_u32 m0, s96, 32768
    s_nop 0
    buffer_load_dwordx4 v20, s[32:35], s67 offen  lds
    s_add_u32 m0, s96, 33792
    s_nop 0
    buffer_load_dwordx4 v21, s[32:35], s67 offen  lds
    s_add_u32 m0, s96, 34816
    s_nop 0
    buffer_load_dwordx4 v22, s[32:35], s67 offen  lds
    s_add_u32 m0, s96, 35840
    s_nop 0
    buffer_load_dwordx4 v23, s[32:35], s67 offen  lds
    s_waitcnt vmcnt(8)
    s_barrier
    s_add_u32 s27, s70, 7
    s_and_b32 s27, s27, 3
    s_add_u32 s27, s27, 20
    s_mul_i32 s71, s27, 851968
    s_add_u32 s71, s71, s98
    s_add_u32 m0, s97, 65536
    s_add_u32 s67, s71, 0
    buffer_load_dwordx4 v8, s[36:39], s67 offen  lds
    s_nop 0
    s_waitcnt lgkmcnt(0)
    v_mfma_f32_32x32x16_bf16 v[132:147], v[116:119], v[84:87], v[132:147]
    ds_read_b128 v[124:127], v219 offset:672
    s_add_u32 m0, s97, 66560
    s_add_u32 s67, s71, 26624
    buffer_load_dwordx4 v8, s[36:39], s67 offen  lds
    ds_read_b128 v[128:131], v219 offset:21904
    v_mul_f32 v100, v56, v35
    v_mul_f32 v101, v56, v36
    v_mul_f32 v102, v56, v37
    s_add_u32 m0, s97, 67584
    s_add_u32 s67, s71, 53248
    buffer_load_dwordx4 v9, s[36:39], s67 offen  lds
    v_mul_f32 v103, v56, v38
    v_mfma_f32_32x32x16_bf16 v[164:179], v[116:119], v[88:91], v[164:179]
    v_cvt_pk_bf16_f32 v92, v100, v101
    v_mul_f32 v104, v56, v39
    s_add_u32 m0, s97, 68608
    s_add_u32 s67, s71, 79872
    buffer_load_dwordx4 v9, s[36:39], s67 offen  lds
    v_mul_f32 v105, v56, v40
    v_cvt_pk_bf16_f32 v93, v102, v103
    v_mul_f32 v106, v56, v41
    v_mul_f32 v107, v56, v42
    s_waitcnt lgkmcnt(0)
    v_lshl_add_u32 v24, v24, 8, v4
    v_lshl_add_u32 v25, v25, 8, v5
    v_lshl_add_u32 v26, v26, 8, v4
    v_lshl_add_u32 v27, v27, 8, v5
    s_mov_b32 s67, s6
    s_add_u32 m0, s96, 65536
    s_nop 0
    buffer_load_dwordx4 v24, s[32:35], s67 offen  lds
    v_cvt_pk_bf16_f32 v94, v104, v105
    v_mfma_f32_32x32x16_bf16 v[148:163], v[120:123], v[84:87], v[148:163]
    v_cvt_pk_bf16_f32 v95, v106, v107
    v_mul_f32 v108, v82, v61
    s_add_u32 m0, s96, 66560
    s_nop 0
    buffer_load_dwordx4 v25, s[32:35], s67 offen  lds
    v_mul_f32 v109, v82, v62
    v_mul_f32 v110, v82, v63
    v_mul_f32 v111, v82, v64
    v_cvt_pk_bf16_f32 v96, v108, v109
    s_add_u32 m0, s96, 67584
    s_nop 0
    buffer_load_dwordx4 v26, s[32:35], s67 offen  lds
    v_mfma_f32_32x32x16_bf16 v[180:195], v[120:123], v[88:91], v[180:195]
    v_mul_f32 v112, v82, v65
    v_mul_f32 v113, v82, v66
    v_cvt_pk_bf16_f32 v97, v110, v111
    s_add_u32 m0, s96, 68608
    s_nop 0
    buffer_load_dwordx4 v27, s[32:35], s67 offen  lds
    v_mul_f32 v114, v82, v67
    v_mul_f32 v115, v82, v68
    v_cvt_pk_bf16_f32 v98, v112, v113
    v_cvt_pk_bf16_f32 v99, v114, v115
    s_add_u32 s26, s70, 8
    s_and_b32 s26, s26, 3
    s_add_u32 s26, s26, 20
    s_lshl_b32 s26, s26, 2
    v_add_u32 v7, s26, v10
    ds_read_b32 v28, v7 offset:0
    ds_read_b32 v29, v7 offset:832
    ds_read_b32 v30, v7 offset:1664
    ds_read_b32 v31, v7 offset:2496
    s_waitcnt vmcnt(8)
    s_barrier
    s_add_u32 s71, s71, s5
    s_add_u32 m0, s97, 0
    s_add_u32 s67, s71, 0
    buffer_load_dwordx4 v8, s[36:39], s67 offen  lds
    s_nop 0
    s_add_u32 m0, s97, 1024
    s_add_u32 s67, s71, 26624
    buffer_load_dwordx4 v8, s[36:39], s67 offen  lds
    s_waitcnt lgkmcnt(0)
    v_mfma_f32_32x32x16_bf16 v[132:147], v[124:127], v[92:95], v[132:147]
    s_add_u32 m0, s97, 2048
    s_add_u32 s67, s71, 53248
    buffer_load_dwordx4 v9, s[36:39], s67 offen  lds
    ds_read_b128 v[120:123], v219 offset:21936
    v_cvt_pk_bf16_f32 v84, v32, v34
    s_add_u32 m0, s97, 3072
    s_add_u32 s67, s71, 79872
    buffer_load_dwordx4 v9, s[36:39], s67 offen  lds
    v_mfma_f32_32x32x16_bf16 v[164:179], v[124:127], v[96:99], v[164:179]
    v_cvt_pk_bf16_f32 v85, v36, v38
    s_mov_b32 s67, s7
    s_add_u32 m0, s96, 0
    s_nop 0
    buffer_load_dwordx4 v24, s[32:35], s67 offen  lds
    v_cvt_pk_bf16_f32 v86, v40, v42
    v_mfma_f32_32x32x16_bf16 v[148:163], v[128:131], v[92:95], v[148:163]
    s_add_u32 m0, s96, 1024
    s_nop 0
    buffer_load_dwordx4 v25, s[32:35], s67 offen  lds
    v_cvt_pk_bf16_f32 v87, v44, v46
    v_cvt_pk_bf16_f32 v88, v58, v60
    s_add_u32 m0, s96, 2048
    s_nop 0
    buffer_load_dwordx4 v26, s[32:35], s67 offen  lds
    v_mfma_f32_32x32x16_bf16 v[180:195], v[128:131], v[96:99], v[180:195]
    v_cvt_pk_bf16_f32 v89, v62, v64
    s_add_u32 m0, s96, 3072
    s_nop 0
    buffer_load_dwordx4 v27, s[32:35], s67 offen  lds
    v_cvt_pk_bf16_f32 v90, v66, v68
    v_cvt_pk_bf16_f32 v91, v70, v72
    s_waitcnt vmcnt(8)
    s_barrier
    s_add_u32 s27, s70, 8
    s_and_b32 s27, s27, 3
    s_add_u32 s27, s27, 20
    s_mul_i32 s71, s27, 851968
    s_add_u32 s71, s71, s98
    s_add_u32 m0, s97, 32768
    s_add_u32 s67, s71, 0
    buffer_load_dwordx4 v8, s[36:39], s67 offen  lds
    s_nop 0
    s_add_u32 m0, s97, 33792
    s_add_u32 s67, s71, 26624
    buffer_load_dwordx4 v8, s[36:39], s67 offen  lds
    s_waitcnt lgkmcnt(0)
    v_mfma_f32_32x32x16_bf16 v[148:163], v[120:123], v[84:87], v[148:163]
    s_add_u32 m0, s97, 34816
    s_add_u32 s67, s71, 53248
    buffer_load_dwordx4 v9, s[36:39], s67 offen  lds
    ds_read_b128 v[128:131], v219 offset:21968
    s_add_u32 m0, s97, 35840
    s_add_u32 s67, s71, 79872
    buffer_load_dwordx4 v9, s[36:39], s67 offen  lds
    v_cvt_pk_bf16_f32 v92, v48, v50
    v_cvt_pk_bf16_f32 v93, v52, v54
    s_waitcnt lgkmcnt(0)
    v_lshl_add_u32 v28, v28, 8, v4
    v_lshl_add_u32 v29, v29, 8, v5
    v_lshl_add_u32 v30, v30, 8, v4
    v_lshl_add_u32 v31, v31, 8, v5
    s_mov_b32 s67, s6
    s_add_u32 m0, s96, 32768
    s_nop 0
    buffer_load_dwordx4 v28, s[32:35], s67 offen  lds
    v_cvt_pk_bf16_f32 v94, v56, v32
    v_mfma_f32_32x32x16_bf16 v[180:195], v[120:123], v[88:91], v[180:195]
    s_add_u32 m0, s96, 33792
    s_nop 0
    buffer_load_dwordx4 v29, s[32:35], s67 offen  lds
    v_cvt_pk_bf16_f32 v95, v32, v32
    s_add_u32 m0, s96, 34816
    s_nop 0
    buffer_load_dwordx4 v30, s[32:35], s67 offen  lds
    v_cvt_pk_bf16_f32 v96, v74, v76
    v_cvt_pk_bf16_f32 v97, v78, v80
    s_add_u32 m0, s96, 35840
    s_nop 0
    buffer_load_dwordx4 v31, s[32:35], s67 offen  lds
    v_cvt_pk_bf16_f32 v98, v82, v58
    v_cvt_pk_bf16_f32 v99, v58, v58
    s_add_u32 s26, s70, 6
    s_and_b32 s26, s26, 1
    s_add_u32 s26, s26, 24
    s_lshl_b32 s26, s26, 2
    v_add_u32 v7, s26, v10
    ds_read_b32 v16, v7 offset:0
    ds_read_b32 v17, v7 offset:832
    ds_read_b32 v18, v7 offset:1664
    ds_read_b32 v19, v7 offset:2496
    s_waitcnt vmcnt(8)
    s_barrier
    s_add_u32 s71, s71, s5
    s_add_u32 m0, s97, 65536
    s_add_u32 s67, s71, 0
    buffer_load_dwordx4 v8, s[36:39], s67 offen  lds
    s_add_u32 m0, s97, 66560
    s_add_u32 s67, s71, 26624
    buffer_load_dwordx4 v8, s[36:39], s67 offen  lds
    s_nop 0
    s_add_u32 m0, s97, 67584
    s_add_u32 s67, s71, 53248
    buffer_load_dwordx4 v9, s[36:39], s67 offen  lds
    s_add_u32 m0, s97, 68608
    s_add_u32 s67, s71, 79872
    buffer_load_dwordx4 v9, s[36:39], s67 offen  lds
    s_waitcnt lgkmcnt(0)
    s_mov_b32 s67, s7
    s_add_u32 m0, s96, 65536
    s_nop 0
    buffer_load_dwordx4 v28, s[32:35], s67 offen  lds
    s_add_u32 m0, s96, 66560
    s_nop 0
    buffer_load_dwordx4 v29, s[32:35], s67 offen  lds
    v_mfma_f32_32x32x16_bf16 v[148:163], v[128:131], v[92:95], v[148:163]
    s_add_u32 m0, s96, 67584
    s_nop 0
    buffer_load_dwordx4 v30, s[32:35], s67 offen  lds
    s_add_u32 m0, s96, 68608
    s_nop 0
    buffer_load_dwordx4 v31, s[32:35], s67 offen  lds
    v_mfma_f32_32x32x16_bf16 v[180:195], v[128:131], v[96:99], v[180:195]
    s_waitcnt vmcnt(8)
    s_barrier
    s_add_u32 s27, s70, 6
    s_and_b32 s27, s27, 1
    s_add_u32 s27, s27, 24
    s_mul_i32 s71, s27, 851968
    s_add_u32 s71, s71, s98
    s_add_u32 m0, s97, 0
    s_add_u32 s67, s71, 0
    buffer_load_dwordx4 v8, s[36:39], s67 offen  lds
    s_add_u32 m0, s97, 1024
    s_add_u32 s67, s71, 26624
    buffer_load_dwordx4 v8, s[36:39], s67 offen  lds
    s_add_u32 m0, s97, 2048
    s_add_u32 s67, s71, 53248
    buffer_load_dwordx4 v9, s[36:39], s67 offen  lds
    s_add_u32 m0, s97, 3072
    s_add_u32 s67, s71, 79872
    buffer_load_dwordx4 v9, s[36:39], s67 offen  lds
    s_waitcnt lgkmcnt(0)
    v_lshl_add_u32 v16, v16, 8, v4
    v_lshl_add_u32 v17, v17, 8, v5
    v_lshl_add_u32 v18, v18, 8, v4
    v_lshl_add_u32 v19, v19, 8, v5
    s_mov_b32 s67, s6
    s_add_u32 m0, s96, 0
    s_nop 0
    buffer_load_dwordx4 v16, s[32:35], s67 offen  lds
    s_add_u32 m0, s96, 1024
    s_nop 0
    buffer_load_dwordx4 v17, s[32:35], s67 offen  lds
    s_add_u32 m0, s96, 2048
    s_nop 0
    buffer_load_dwordx4 v18, s[32:35], s67 offen  lds
    s_add_u32 m0, s96, 3072
    s_nop 0
    buffer_load_dwordx4 v19, s[32:35], s67 offen  lds
    s_add_u32 s26, s70, 7
    s_and_b32 s26, s26, 1
    s_add_u32 s26, s26, 24
    s_lshl_b32 s26, s26, 2
    v_add_u32 v7, s26, v10
    ds_read_b32 v20, v7 offset:0
    ds_read_b32 v21, v7 offset:832
    ds_read_b32 v22, v7 offset:1664
    ds_read_b32 v23, v7 offset:2496
    s_waitcnt vmcnt(8)
    s_barrier
    s_add_u32 s71, s71, s5
    s_add_u32 m0, s97, 32768
    s_add_u32 s67, s71, 0
    buffer_load_dwordx4 v8, s[36:39], s67 offen  lds
    s_add_u32 m0, s97, 33792
    s_add_u32 s67, s71, 26624
    buffer_load_dwordx4 v8, s[36:39], s67 offen  lds
    s_add_u32 m0, s97, 34816
    s_add_u32 s67, s71, 53248
    buffer_load_dwordx4 v9, s[36:39], s67 offen  lds
    s_add_u32 m0, s97, 35840
    s_add_u32 s67, s71, 79872
    buffer_load_dwordx4 v9, s[36:39], s67 offen  lds
    s_mov_b32 s67, s7
    s_add_u32 m0, s96, 32768
    s_nop 0
    buffer_load_dwordx4 v16, s[32:35], s67 offen  lds
    s_add_u32 m0, s96, 33792
    s_nop 0
    buffer_load_dwordx4 v17, s[32:35], s67 offen  lds
    s_add_u32 m0, s96, 34816
    s_nop 0
    buffer_load_dwordx4 v18, s[32:35], s67 offen  lds
    s_add_u32 m0, s96, 35840
    s_nop 0
    buffer_load_dwordx4 v19, s[32:35], s67 offen  lds
    s_waitcnt vmcnt(8)
    s_barrier
    s_add_u32 s27, s70, 7
    s_and_b32 s27, s27, 1
    s_add_u32 s27, s27, 24
    s_mul_i32 s71, s27, 851968
    s_add_u32 s71, s71, s98
    s_add_u32 m0, s97, 65536
    s_add_u32 s67, s71, 0
    buffer_load_dwordx4 v8, s[36:39], s67 offen  lds
    s_add_u32 m0, s97, 66560
    s_add_u32 s67, s71, 26624
    buffer_load_dwordx4 v8, s[36:39], s67 offen  lds
    s_add_u32 m0, s97, 67584
    s_add_u32 s67, s71, 53248
    buffer_load_dwordx4 v9, s[36:39], s67 offen  lds
    s_add_u32 m0, s97, 68608
    s_add_u32 s67, s71, 79872
    buffer_load_dwordx4 v9, s[36:39], s67 offen  lds
    s_waitcnt lgkmcnt(0)
    v_lshl_add_u32 v20, v20, 8, v4
    v_lshl_add_u32 v21, v21, 8, v5
    v_lshl_add_u32 v22, v22, 8, v4
    v_lshl_add_u32 v23, v23, 8, v5
    s_mov_b32 s67, s6
    s_add_u32 m0, s96, 65536
    s_nop 0
    buffer_load_dwordx4 v20, s[32:35], s67 offen  lds
    s_add_u32 m0, s96, 66560
    s_nop 0
    buffer_load_dwordx4 v21, s[32:35], s67 offen  lds
    s_add_u32 m0, s96, 67584
    s_nop 0
    buffer_load_dwordx4 v22, s[32:35], s67 offen  lds
    s_add_u32 m0, s96, 68608
    s_nop 0
    buffer_load_dwordx4 v23, s[32:35], s67 offen  lds
    s_waitcnt vmcnt(8)
    s_barrier
    s_add_u32 s71, s71, s5
    s_add_u32 m0, s97, 0
    s_add_u32 s67, s71, 0
    buffer_load_dwordx4 v8, s[36:39], s67 offen  lds
    s_add_u32 m0, s97, 1024
    s_add_u32 s67, s71, 26624
    buffer_load_dwordx4 v8, s[36:39], s67 offen  lds
    s_add_u32 m0, s97, 2048
    s_add_u32 s67, s71, 53248
    buffer_load_dwordx4 v9, s[36:39], s67 offen  lds
    s_add_u32 m0, s97, 3072
    s_add_u32 s67, s71, 79872
    buffer_load_dwordx4 v9, s[36:39], s67 offen  lds
    s_mov_b32 s67, s7
    s_add_u32 m0, s96, 0
    s_nop 0
    buffer_load_dwordx4 v20, s[32:35], s67 offen  lds
    s_add_u32 m0, s96, 1024
    s_nop 0
    buffer_load_dwordx4 v21, s[32:35], s67 offen  lds
    s_add_u32 m0, s96, 2048
    s_nop 0
    buffer_load_dwordx4 v22, s[32:35], s67 offen  lds
    s_add_u32 m0, s96, 3072
    s_nop 0
    buffer_load_dwordx4 v23, s[32:35], s67 offen  lds
    s_waitcnt vmcnt(8)
    s_barrier
    s_waitcnt vmcnt(0)
    s_barrier
    s_nop 11
    v_mul_f32 v212, v132, v148
    v_mul_f32 v213, v164, v180
    v_fmac_f32 v212, v133, v149
    v_fmac_f32 v213, v165, v181
    v_fmac_f32 v212, v134, v150
    v_fmac_f32 v213, v166, v182
    v_fmac_f32 v212, v135, v151
    v_fmac_f32 v213, v167, v183
    v_fmac_f32 v212, v136, v152
    v_fmac_f32 v213, v168, v184
    v_fmac_f32 v212, v137, v153
    v_fmac_f32 v213, v169, v185
    v_fmac_f32 v212, v138, v154
    v_fmac_f32 v213, v170, v186
    v_fmac_f32 v212, v139, v155
    v_fmac_f32 v213, v171, v187
    v_fmac_f32 v212, v140, v156
    v_fmac_f32 v213, v172, v188
    v_fmac_f32 v212, v141, v157
    v_fmac_f32 v213, v173, v189
    v_fmac_f32 v212, v142, v158
    v_fmac_f32 v213, v174, v190
    v_fmac_f32 v212, v143, v159
    v_fmac_f32 v213, v175, v191
    v_fmac_f32 v212, v144, v160
    v_fmac_f32 v213, v176, v192
    v_fmac_f32 v212, v145, v161
    v_fmac_f32 v213, v177, v193
    v_add_f32 v212, v212, v213
    s_nop 1
    v_add_f32_dpp v212, v212, v212 row_shr:1 row_mask:0xf bank_mask:0xf bound_ctrl:0
    s_nop 1
    v_add_f32_dpp v212, v212, v212 row_shr:2 row_mask:0xf bank_mask:0xf bound_ctrl:0
    s_nop 1
    v_add_f32_dpp v212, v212, v212 row_shr:4 row_mask:0xf bank_mask:0xf bound_ctrl:0
    s_nop 1
    v_add_f32_dpp v212, v212, v212 row_shr:8 row_mask:0xf bank_mask:0xf bound_ctrl:0
    s_nop 1
    v_add_f32_dpp v212, v212, v212 row_bcast:15 row_mask:0xa bank_mask:0xf
    s_nop 1
    v_add_f32_dpp v212, v212, v212 row_bcast:31 row_mask:0xc bank_mask:0xf
    v_cmp_eq_u32 vcc, 63, v0
    s_lshr_b32 s68, s99, 1
    s_lshl1_add_u32 s68, s62, s68
    s_add_u32 s68, s68, s63
    v_mov_b32 v13, 512
    v_cndmask_b32 v212, 0, v212, vcc
    v_cndmask_b32 v12, v13, 0, vcc
    s_sub_u32 s68, s68, s63
    s_and_b32 s69, s99, 1
    s_lshl_b32 s69, s69, 8
    s_add_u32 s69, s69, 6656
    s_add_u32 s69, s69, s68
    s_mul_i32 s68, s61, 28672
    s_lshl2_add_u32 s69, s69, s68
    s_mov_b32 exec_lo, 0
    s_mov_b32 exec_hi, 3221225472
    buffer_store_dword v212, v12, s[48:51], s69 offen sc1
    s_mov_b64 exec, -1
    s_waitcnt vmcnt(0)
L_join:
    s_barrier
    s_cmp_lg_u32 s60, 0
    s_cbranch_scc1 L_fin
    s_mul_i32 s66, s61, 4352
    s_add_u32 s66, s66, 786432
    v_mov_b32 v1, 0
    v_mov_b32 v2, 1
    s_mov_b64 exec, 1
    buffer_atomic_add v2, v1, s[48:51], s66 offen sc0
    s_mov_b32 s40, s18
    s_and_b32 s41, s19, 0xffff
    s_mov_b32 s42, 2
    s_mov_b32 s43, 0x20000
    buffer_load_ushort v4, v1, s[40:43], 0 offen
    s_waitcnt vmcnt(0)
    s_mov_b64 exec, -1
    v_readfirstlane_b32 s67, v2
    v_readfirstlane_b32 s68, v4
    s_cmp_lg_u32 s67, 31
    s_cbranch_scc1 L_fin
    v_lshlrev_b32 v1, 4, v0
    s_mul_i32 s66, s61, 28672
    buffer_load_dwordx4 v[16:19], v1, s[48:51], s66 offen offset:0 sc1
    buffer_load_dwordx4 v[20:23], v1, s[48:51], s66 offen offset:1024 sc1
    buffer_load_dwordx4 v[24:27], v1, s[48:51], s66 offen offset:2048 sc1
    buffer_load_dwordx4 v[28:31], v1, s[48:51], s66 offen offset:3072 sc1
    s_add_u32 s66, s66, 4096
    buffer_load_dwordx4 v[32:35], v1, s[48:51], s66 offen offset:0 sc1
    buffer_load_dwordx4 v[36:39], v1, s[48:51], s66 offen offset:1024 sc1
    buffer_load_dwordx4 v[40:43], v1, s[48:51], s66 offen offset:2048 sc1
    buffer_load_dwordx4 v[44:47], v1, s[48:51], s66 offen offset:3072 sc1
    s_add_u32 s66, s66, 4096
    buffer_load_dwordx4 v[48:51], v1, s[48:51], s66 offen offset:0 sc1
    buffer_load_dwordx4 v[52:55], v1, s[48:51], s66 offen offset:1024 sc1
    buffer_load_dwordx4 v[56:59], v1, s[48:51], s66 offen offset:2048 sc1
    buffer_load_dwordx4 v[60:63], v1, s[48:51], s66 offen offset:3072 sc1
    s_add_u32 s66, s66, 4096
    buffer_load_dwordx4 v[64:67], v1, s[48:51], s66 offen offset:0 sc1
    buffer_load_dwordx4 v[68:71], v1, s[48:51], s66 offen offset:1024 sc1
    buffer_load_dwordx4 v[72:75], v1, s[48:51], s66 offen offset:2048 sc1
    buffer_load_dwordx4 v[76:79], v1, s[48:51], s66 offen offset:3072 sc1
    s_add_u32 s66, s66, 4096
    buffer_load_dwordx4 v[80:83], v1, s[48:51], s66 offen offset:0 sc1
    buffer_load_dwordx4 v[84:87], v1, s[48:51], s66 offen offset:1024 sc1
    buffer_load_dwordx4 v[88:91], v1, s[48:51], s66 offen offset:2048 sc1
    buffer_load_dwordx4 v[92:95], v1, s[48:51], s66 offen offset:3072 sc1
    s_add_u32 s66, s66, 4096
    buffer_load_dwordx4 v[96:99], v1, s[48:51], s66 offen offset:0 sc1
    buffer_load_dwordx4 v[100:103], v1, s[48:51], s66 offen offset:1024 sc1
    buffer_load_dwordx4 v[104:107], v1, s[48:51], s66 offen offset:2048 sc1
    buffer_load_dwordx4 v[108:111], v1, s[48:51], s66 offen offset:3072 sc1
    s_add_u32 s66, s66, 4096
    buffer_load_dwordx4 v[112:115], v1, s[48:51], s66 offen offset:0 sc1
    buffer_load_dwordx4 v[116:119], v1, s[48:51], s66 offen offset:1024 sc1
    buffer_load_dwordx4 v[120:123], v1, s[48:51], s66 offen offset:2048 sc1
    buffer_load_dwordx4 v[124:127], v1, s[48:51], s66 offen offset:3072 sc1
    s_add_u32 s66, s66, 4096
    s_lshl_b32 s68, s68, 16
    v_lshlrev_b32 v1, 3, v0
    s_lshl_b32 s66, s63, 1
    s_waitcnt vmcnt(24)
    v_pk_add_f32 v[16:17], v[16:17], v[20:21]
    v_pk_add_f32 v[18:19], v[18:19], v[22:23]
    v_pk_add_f32 v[16:17], v[16:17], v[24:25]
    v_pk_add_f32 v[18:19], v[18:19], v[26:27]
    v_pk_add_f32 v[16:17], v[16:17], v[28:29]
    v_pk_add_f32 v[18:19], v[18:19], v[30:31]
    s_waitcnt vmcnt(21)
    v_pk_add_f32 v[16:17], v[16:17], v[32:33]
    v_pk_add_f32 v[18:19], v[18:19], v[34:35]
    v_pk_add_f32 v[16:17], v[16:17], v[36:37]
    v_pk_add_f32 v[18:19], v[18:19], v[38:39]
    v_pk_add_f32 v[16:17], v[16:17], v[40:41]
    v_pk_add_f32 v[18:19], v[18:19], v[42:43]
    s_waitcnt vmcnt(18)
    v_pk_add_f32 v[16:17], v[16:17], v[44:45]
    v_pk_add_f32 v[18:19], v[18:19], v[46:47]
    v_pk_add_f32 v[16:17], v[16:17], v[48:49]
    v_pk_add_f32 v[18:19], v[18:19], v[50:51]
    v_pk_add_f32 v[16:17], v[16:17], v[52:53]
    v_pk_add_f32 v[18:19], v[18:19], v[54:55]
    s_waitcnt vmcnt(15)
    v_pk_add_f32 v[16:17], v[16:17], v[56:57]
    v_pk_add_f32 v[18:19], v[18:19], v[58:59]
    v_pk_add_f32 v[16:17], v[16:17], v[60:61]
    v_pk_add_f32 v[18:19], v[18:19], v[62:63]
    v_pk_add_f32 v[16:17], v[16:17], v[64:65]
    v_pk_add_f32 v[18:19], v[18:19], v[66:67]
    s_waitcnt vmcnt(12)
    v_pk_add_f32 v[16:17], v[16:17], v[68:69]
    v_pk_add_f32 v[18:19], v[18:19], v[70:71]
    v_pk_add_f32 v[16:17], v[16:17], v[72:73]
    v_pk_add_f32 v[18:19], v[18:19], v[74:75]
    v_pk_add_f32 v[16:17], v[16:17], v[76:77]
    v_pk_add_f32 v[18:19], v[18:19], v[78:79]
    s_waitcnt vmcnt(9)
    v_pk_add_f32 v[16:17], v[16:17], v[80:81]
    v_pk_add_f32 v[18:19], v[18:19], v[82:83]
    v_pk_add_f32 v[16:17], v[16:17], v[84:85]
    v_pk_add_f32 v[18:19], v[18:19], v[86:87]
    v_pk_add_f32 v[16:17], v[16:17], v[88:89]
    v_pk_add_f32 v[18:19], v[18:19], v[90:91]
    s_waitcnt vmcnt(6)
    v_pk_add_f32 v[16:17], v[16:17], v[92:93]
    v_pk_add_f32 v[18:19], v[18:19], v[94:95]
    v_pk_add_f32 v[16:17], v[16:17], v[96:97]
    v_pk_add_f32 v[18:19], v[18:19], v[98:99]
    v_pk_add_f32 v[16:17], v[16:17], v[100:101]
    v_pk_add_f32 v[18:19], v[18:19], v[102:103]
    s_waitcnt vmcnt(3)
    v_pk_add_f32 v[16:17], v[16:17], v[104:105]
    v_pk_add_f32 v[18:19], v[18:19], v[106:107]
    v_pk_add_f32 v[16:17], v[16:17], v[108:109]
    v_pk_add_f32 v[18:19], v[18:19], v[110:111]
    v_pk_add_f32 v[16:17], v[16:17], v[112:113]
    v_pk_add_f32 v[18:19], v[18:19], v[114:115]
    s_waitcnt vmcnt(0)
    v_pk_add_f32 v[16:17], v[16:17], v[116:117]
    v_pk_add_f32 v[18:19], v[18:19], v[118:119]
    v_pk_add_f32 v[16:17], v[16:17], v[120:121]
    v_pk_add_f32 v[18:19], v[18:19], v[122:123]
    v_pk_add_f32 v[16:17], v[16:17], v[124:125]
    v_pk_add_f32 v[18:19], v[18:19], v[126:127]
    v_mov_b32 v20, v16
    v_mov_b32 v21, v17
    v_mov_b32 v22, v18
    v_mov_b32 v23, v19
    s_nop 1
    v_permlane32_swap_b32 v16, v20
    v_permlane32_swap_b32 v17, v21
    v_permlane32_swap_b32 v18, v22
    v_permlane32_swap_b32 v19, v23
    s_nop 1
    v_add_f32 v16, v16, v20
    v_add_f32 v17, v17, v21
    v_add_f32 v18, v18, v22
    v_add_f32 v19, v19, v23
    v_add_f32 v16, s68, v16
    v_add_f32 v17, s68, v17
    v_add_f32 v18, s68, v18
    v_add_f32 v19, s68, v19
    v_cvt_pk_bf16_f32 v2, v16, v17
    v_cvt_pk_bf16_f32 v3, v18, v19
    s_mov_b32 exec_hi, 0
    buffer_store_dwordx2 v[2:3], v1, s[56:59], s66 offen
    s_mov_b64 exec, -1
L_fin:
    s_endpgm
L_cin:
    s_mov_b32 s61, s66
    s_lshl_b32 s63, s61, 7
    v_lshlrev_b32 v1, 4, v0
    s_cmp_eq_u32 s60, 7
    s_cbranch_scc1 L_scout
    s_mov_b32 s36, s8
    s_and_b32 s37, s9, 0xffff
    s_mov_b32 s38, 105456
    s_mov_b32 s39, 0x20000
    s_mov_b32 s40, s10
    s_and_b32 s41, s11, 0xffff
    s_mov_b32 s42, 156
    s_mov_b32 s43, 0x20000
    s_mov_b32 s44, s10
    s_and_b32 s45, s11, 0xffff
    s_mov_b32 s46, 52
    s_mov_b32 s47, 0x20000
    s_lshl_b32 s68, s60, 6
    v_add_u32 v15, s68, v0
    v_and_b32 v2, 31, v0
    v_lshrrev_b32 v3, 5, v0
    v_mov_b32 v230, 0
    v_mov_b32 v231, 1
    s_cmp_ge_u32 s2, 26
    s_cbranch_scc1 L_cw1
    s_cmp_eq_u32 s60, 6
    s_cbranch_scc1 L_cq6
    v_lshlrev_b32 v92, 1, v0
    buffer_load_ushort v14, v92, s[40:43], 0 offen offset:104
    v_lshlrev_b32 v92, 2, v15
    v_cmp_gt_u32 vcc, 338, v15
    v_mov_b32 v93, 2146435072
    s_mov_b32 s69, 70304
    v_cndmask_b32 v92, v93, v92, vcc
    buffer_load_dword v192, v92, s[36:39], s69 offen offset:0
    buffer_load_dword v193, v92, s[36:39], s69 offen offset:1352
    buffer_load_dword v194, v92, s[36:39], s69 offen offset:2704
    s_add_u32 s69, s69, 4056
    buffer_load_dword v195, v92, s[36:39], s69 offen offset:0
    buffer_load_dword v196, v92, s[36:39], s69 offen offset:1352
    buffer_load_dword v197, v92, s[36:39], s69 offen offset:2704
    s_add_u32 s69, s69, 4056
    buffer_load_dword v198, v92, s[36:39], s69 offen offset:0
    buffer_load_dword v199, v92, s[36:39], s69 offen offset:1352
    buffer_load_dword v200, v92, s[36:39], s69 offen offset:2704
    s_add_u32 s69, s69, 4056
    buffer_load_dword v201, v92, s[36:39], s69 offen offset:0
    buffer_load_dword v202, v92, s[36:39], s69 offen offset:1352
    buffer_load_dword v203, v92, s[36:39], s69 offen offset:2704
    s_add_u32 s69, s69, 4056
    buffer_load_dword v204, v92, s[36:39], s69 offen offset:0
    buffer_load_dword v205, v92, s[36:39], s69 offen offset:1352
    buffer_load_dword v206, v92, s[36:39], s69 offen offset:2704
    s_add_u32 s69, s69, 4056
    buffer_load_dword v207, v92, s[36:39], s69 offen offset:0
    buffer_load_dword v208, v92, s[36:39], s69 offen offset:1352
    buffer_load_dword v209, v92, s[36:39], s69 offen offset:2704
    s_add_u32 s69, s69, 4056
    buffer_load_dword v210, v92, s[36:39], s69 offen offset:0
    buffer_load_dword v211, v92, s[36:39], s69 offen offset:1352
    buffer_load_dword v212, v92, s[36:39], s69 offen offset:2704
    s_add_u32 s69, s69, 4056
    buffer_load_dword v213, v92, s[36:39], s69 offen offset:0
    buffer_load_dword v214, v92, s[36:39], s69 offen offset:1352
    buffer_load_dword v215, v92, s[36:39], s69 offen offset:2704
    s_add_u32 s69, s69, 4056
    buffer_load_dword v216, v92, s[36:39], s69 offen offset:0
    buffer_load_dword v217, v92, s[36:39], s69 offen offset:1352
    s_mul_i32 s26, s67, 3320491
    s_add_u32 s27, s26, 3320491
    s_lshr_b32 s26, s26, 16
    s_lshr_b32 s27, s27, 16
    s_lshl_b32 s67, s60, 3
    s_mov_b32 s68, 4280423431
    s_mov_b32 s69, 2693902
    s_lshr_b64 s[68:69], s[68:69], s67
    s_and_b32 s68, s68, 255
    s_add_u32 s68, s68, s26
    s_min_u32 s27, s27, s68
    s_mov_b32 s68, 689638912
    s_mov_b32 s69, 2233351
    s_lshr_b64 s[68:69], s[68:69], s67
    s_and_b32 s68, s68, 255
    s_add_u32 s26, s26, s68
    s_add_u32 s26, s26, 208
    s_add_u32 s27, s27, 208
    v_lshrrev_b32 v9, 2, v0
    v_lshlrev_b32 v4, 2, v9
    v_add_u32 v9, 16, v9
    v_subrev_u32 v11, 26, v9
    v_min_u32 v9, v9, v11
    v_lshlrev_b32 v5, 2, v9
    s_add_u32 s69, s26, 0
    s_lshr_b32 s69, s69, 2
    s_add_u32 s69, s69, s63
    s_mul_i32 s69, s69, 104
    buffer_load_dword v6, v4, s[28:31], s69 offen
    buffer_load_dword v7, v5, s[28:31], s69 offen
    v_lshlrev_b32 v9, 3, v3
    buffer_load_dwordx2 v[84:85], v9, s[44:47], 0 offen offset:0
    buffer_load_dwordx2 v[86:87], v9, s[44:47], 0 offen offset:16
    buffer_load_dwordx2 v[88:89], v9, s[44:47], 0 offen offset:32
    buffer_load_dwordx2 v[90:91], v9, s[44:47], 0 offen offset:48
    s_barrier
    v_and_b32 v9, 3, v0
    v_lshlrev_b32 v13, 4, v9
    s_lshl_b32 s65, s60, 12
    s_add_u32 s65, s65, 49152
    s_mov_b32 s70, 0
    v_lshlrev_b32 v9, 1, v2
    v_add_u32 v9, s65, v9
    v_lshl_add_u32 v10, v3, 6, v9
    v_and_b32 v9, 31, v0
    v_mul_u32_u24 v12, 784, v9
    v_lshlrev_b32 v9, 4, v9
    v_add_u32 v9, 19968, v9
    v_min_u32 v12, v12, v9
    v_lshrrev_b32 v11, 5, v0
    v_lshl_add_u32 v12, v11, 4, v12
    v_mov_b32 v32, 0
    v_mov_b32 v33, 0
    v_mov_b32 v34, 0
    v_mov_b32 v35, 0
    v_mov_b32 v36, 0
    v_mov_b32 v37, 0
    v_mov_b32 v38, 0
    v_mov_b32 v39, 0
    v_mov_b32 v40, 0
    v_mov_b32 v41, 0
    v_mov_b32 v42, 0
    v_mov_b32 v43, 0
    v_mov_b32 v44, 0
    v_mov_b32 v45, 0
    v_mov_b32 v46, 0
    v_mov_b32 v47, 0
    v_mov_b32 v48, 0
    v_mov_b32 v49, 0
    v_mov_b32 v50, 0
    v_mov_b32 v51, 0
    v_mov_b32 v52, 0
    v_mov_b32 v53, 0
    v_mov_b32 v54, 0
    v_mov_b32 v55, 0
    v_mov_b32 v56, 0
    v_mov_b32 v57, 0
    v_mov_b32 v58, 0
    v_mov_b32 v59, 0
    v_mov_b32 v60, 0
    v_mov_b32 v61, 0
    v_mov_b32 v62, 0
    v_mov_b32 v63, 0
    v_mov_b32 v64, 0
    v_mov_b32 v65, 0
    v_mov_b32 v66, 0
    v_mov_b32 v67, 0
    v_mov_b32 v68, 0
    v_mov_b32 v69, 0
    v_mov_b32 v70, 0
    v_mov_b32 v71, 0
    v_mov_b32 v72, 0
    v_mov_b32 v73, 0
    v_mov_b32 v74, 0
    v_mov_b32 v75, 0
    v_mov_b32 v76, 0
    v_mov_b32 v77, 0
    v_mov_b32 v78, 0
    v_mov_b32 v79, 0
    v_mov_b32 v80, 0
    v_mov_b32 v81, 0
    v_mov_b32 v82, 0
    v_mov_b32 v83, 0
    v_mul_u32_u24 v92, 5042, v15
    v_lshrrev_b32 v92, 16, v92
    v_mul_u32_u24 v93, 13, v92
    v_sub_u32 v93, v15, v93
    v_lshlrev_b32 v93, 7, v93
    v_lshl_add_u32 v93, v92, 1, v93
    v_add_u32 v93, 81920, v93
    v_mov_b32 v164, 0
    v_mov_b32 v165, 0
    s_waitcnt vmcnt(32)
    v_lshlrev_b32 v14, 16, v14
    s_nop 0
    v_readlane_b32 s69, v14, 0
    s_waitcnt vmcnt(31)
    v_lshlrev_b32 v166, 16, v192
    v_and_b32 v167, 0xffff0000, v192
    v_fmac_f32 v164, s69, v166
    v_fmac_f32 v165, s69, v167
    v_readlane_b32 s69, v14, 1
    s_waitcnt vmcnt(30)
    v_lshlrev_b32 v166, 16, v193
    v_and_b32 v167, 0xffff0000, v193
    v_fmac_f32 v164, s69, v166
    v_fmac_f32 v165, s69, v167
    v_readlane_b32 s69, v14, 2
    s_waitcnt vmcnt(29)
    v_lshlrev_b32 v166, 16, v194
    v_and_b32 v167, 0xffff0000, v194
    v_fmac_f32 v164, s69, v166
    v_fmac_f32 v165, s69, v167
    v_readlane_b32 s69, v14, 3
    s_waitcnt vmcnt(28)
    v_lshlrev_b32 v166, 16, v195
    v_and_b32 v167, 0xffff0000, v195
    v_fmac_f32 v164, s69, v166
    v_fmac_f32 v165, s69, v167
    v_readlane_b32 s69, v14, 4
    s_waitcnt vmcnt(27)
    v_lshlrev_b32 v166, 16, v196
    v_and_b32 v167, 0xffff0000, v196
    v_fmac_f32 v164, s69, v166
    v_fmac_f32 v165, s69, v167
    v_readlane_b32 s69, v14, 5
    s_waitcnt vmcnt(26)
    v_lshlrev_b32 v166, 16, v197
    v_and_b32 v167, 0xffff0000, v197
    v_fmac_f32 v164, s69, v166
    v_fmac_f32 v165, s69, v167
    v_readlane_b32 s69, v14, 6
    s_waitcnt vmcnt(25)
    v_lshlrev_b32 v166, 16, v198
    v_and_b32 v167, 0xffff0000, v198
    v_fmac_f32 v164, s69, v166
    v_fmac_f32 v165, s69, v167
    v_readlane_b32 s69, v14, 7
    s_waitcnt vmcnt(24)
    v_lshlrev_b32 v166, 16, v199
    v_and_b32 v167, 0xffff0000, v199
    v_fmac_f32 v164, s69, v166
    v_fmac_f32 v165, s69, v167
    v_readlane_b32 s69, v14, 8
    s_waitcnt vmcnt(23)
    v_lshlrev_b32 v166, 16, v200
    v_and_b32 v167, 0xffff0000, v200
    v_fmac_f32 v164, s69, v166
    v_fmac_f32 v165, s69, v167
    v_readlane_b32 s69, v14, 9
    s_waitcnt vmcnt(22)
    v_lshlrev_b32 v166, 16, v201
    v_and_b32 v167, 0xffff0000, v201
    v_fmac_f32 v164, s69, v166
    v_fmac_f32 v165, s69, v167
    v_readlane_b32 s69, v14, 10
    s_waitcnt vmcnt(21)
    v_lshlrev_b32 v166, 16, v202
    v_and_b32 v167, 0xffff0000, v202
    v_fmac_f32 v164, s69, v166
    v_fmac_f32 v165, s69, v167
    v_readlane_b32 s69, v14, 11
    s_waitcnt vmcnt(20)
    v_lshlrev_b32 v166, 16, v203
    v_and_b32 v167, 0xffff0000, v203
    v_fmac_f32 v164, s69, v166
    v_fmac_f32 v165, s69, v167
    v_readlane_b32 s69, v14, 12
    s_waitcnt vmcnt(19)
    v_lshlrev_b32 v166, 16, v204
    v_and_b32 v167, 0xffff0000, v204
    v_fmac_f32 v164, s69, v166
    v_fmac_f32 v165, s69, v167
    v_readlane_b32 s69, v14, 13
    s_waitcnt vmcnt(18)
    v_lshlrev_b32 v166, 16, v205
    v_and_b32 v167, 0xffff0000, v205
    v_fmac_f32 v164, s69, v166
    v_fmac_f32 v165, s69, v167
    v_readlane_b32 s69, v14, 14
    s_waitcnt vmcnt(17)
    v_lshlrev_b32 v166, 16, v206
    v_and_b32 v167, 0xffff0000, v206
    v_fmac_f32 v164, s69, v166
    v_fmac_f32 v165, s69, v167
    v_readlane_b32 s69, v14, 15
    s_waitcnt vmcnt(16)
    v_lshlrev_b32 v166, 16, v207
    v_and_b32 v167, 0xffff0000, v207
    v_fmac_f32 v164, s69, v166
    v_fmac_f32 v165, s69, v167
    v_readlane_b32 s69, v14, 16
    s_waitcnt vmcnt(15)
    v_lshlrev_b32 v166, 16, v208
    v_and_b32 v167, 0xffff0000, v208
    v_fmac_f32 v164, s69, v166
    v_fmac_f32 v165, s69, v167
    v_readlane_b32 s69, v14, 17
    s_waitcnt vmcnt(14)
    v_lshlrev_b32 v166, 16, v209
    v_and_b32 v167, 0xffff0000, v209
    v_fmac_f32 v164, s69, v166
    v_fmac_f32 v165, s69, v167
    v_readlane_b32 s69, v14, 18
    s_waitcnt vmcnt(13)
    v_lshlrev_b32 v166, 16, v210
    v_and_b32 v167, 0xffff0000, v210
    v_fmac_f32 v164, s69, v166
    v_fmac_f32 v165, s69, v167
    v_readlane_b32 s69, v14, 19
    s_waitcnt vmcnt(12)
    v_lshlrev_b32 v166, 16, v211
    v_and_b32 v167, 0xffff0000, v211
    v_fmac_f32 v164, s69, v166
    v_fmac_f32 v165, s69, v167
    v_readlane_b32 s69, v14, 20
    s_waitcnt vmcnt(11)
    v_lshlrev_b32 v166, 16, v212
    v_and_b32 v167, 0xffff0000, v212
    v_fmac_f32 v164, s69, v166
    v_fmac_f32 v165, s69, v167
    v_readlane_b32 s69, v14, 21
    s_waitcnt vmcnt(10)
    v_lshlrev_b32 v166, 16, v213
    v_and_b32 v167, 0xffff0000, v213
    v_fmac_f32 v164, s69, v166
    v_fmac_f32 v165, s69, v167
    v_readlane_b32 s69, v14, 22
    s_waitcnt vmcnt(9)
    v_lshlrev_b32 v166, 16, v214
    v_and_b32 v167, 0xffff0000, v214
    v_fmac_f32 v164, s69, v166
    v_fmac_f32 v165, s69, v167
    v_readlane_b32 s69, v14, 23
    s_waitcnt vmcnt(8)
    v_lshlrev_b32 v166, 16, v215
    v_and_b32 v167, 0xffff0000, v215
    v_fmac_f32 v164, s69, v166
    v_fmac_f32 v165, s69, v167
    v_readlane_b32 s69, v14, 24
    s_waitcnt vmcnt(7)
    v_lshlrev_b32 v166, 16, v216
    v_and_b32 v167, 0xffff0000, v216
    v_fmac_f32 v164, s69, v166
    v_fmac_f32 v165, s69, v167
    v_readlane_b32 s69, v14, 25
    s_waitcnt vmcnt(6)
    v_lshlrev_b32 v166, 16, v217
    v_and_b32 v167, 0xffff0000, v217
    v_fmac_f32 v164, s69, v166
    v_fmac_f32 v165, s69, v167
    v_cvt_pk_bf16_f32 v164, v164, v165
    s_mov_b64 exec, vcc
    ds_write_b16 v93, v164
    ds_write_b16_d16_hi v93, v164 offset:64
    s_waitcnt lgkmcnt(0)
    s_mov_b64 exec, 1
    ds_add_u32 v230, v231 offset:44032
    s_mov_b64 exec, -1
    s_branch L_cp1
L_cq6:
    s_getpc_b64 s[4:5]
    s_add_u32 s4, s4, cin_scatter_tab@rel32@lo+4
    s_addc_u32 s5, s5, cin_scatter_tab@rel32@hi+12
    v_cmp_gt_u32 vcc, 26, v2
    v_mov_b32 v93, 2146435072
    v_mov_b32 v164, 0
    v_mov_b32 v165, 0
    v_mov_b32 v166, 0
    v_mov_b32 v167, 0
    s_sub_u32 s66, s60, 5
    s_lshl_b32 s66, s66, 10
    s_add_u32 s66, s66, 83968
    v_add_u32 v14, s66, v1
    ds_write_b128 v14, v[164:167]
    s_add_u32 s96, s2, 26
    v_mul_u32_u24 v92, 10816, v3
    v_lshl_add_u32 v92, v2, 1, v92
    v_cndmask_b32 v92, v93, v92, vcc
    v_cmp_gt_u32 vcc, 26, v0
    s_mul_i32 s69, s2, 52
    s_add_u32 s69, s69, 35152
    v_cndmask_b32 v93, v93, v92, vcc
    v_lshlrev_b32 v94, 1, v0
    buffer_load_ushort v95, v94, s[40:43], 0 offen offset:52
    s_add_u32 s68, s69, 0
    buffer_load_ushort v148, v92, s[36:39], s68 offen offset:0
    buffer_load_ushort v149, v92, s[36:39], s68 offen offset:1352
    buffer_load_ushort v150, v92, s[36:39], s68 offen offset:2704
    s_add_u32 s68, s69, 4056
    buffer_load_ushort v151, v92, s[36:39], s68 offen offset:0
    buffer_load_ushort v152, v92, s[36:39], s68 offen offset:1352
    buffer_load_ushort v153, v92, s[36:39], s68 offen offset:2704
    s_add_u32 s68, s69, 8112
    buffer_load_ushort v154, v92, s[36:39], s68 offen offset:0
    buffer_load_ushort v155, v92, s[36:39], s68 offen offset:1352
    s_add_u32 s68, s69, 21632
    buffer_load_ushort v156, v92, s[36:39], s68 offen offset:0
    buffer_load_ushort v157, v92, s[36:39], s68 offen offset:1352
    buffer_load_ushort v158, v93, s[36:39], s68 offen offset:2704
    s_add_u32 s68, s69, 25688
    buffer_load_ushort v159, v93, s[36:39], s68 offen offset:0
    buffer_load_ushort v160, v93, s[36:39], s68 offen offset:1352
    buffer_load_ushort v161, v93, s[36:39], s68 offen offset:2704
    s_add_u32 s68, s69, 29744
    buffer_load_ushort v162, v93, s[36:39], s68 offen offset:0
    buffer_load_ushort v163, v93, s[36:39], s68 offen offset:1352
    global_load_dwordx4 v[100:103], v1, s[4:5] offset:0
    global_load_dwordx4 v[104:107], v1, s[4:5] offset:1024
    global_load_dwordx4 v[108:111], v1, s[4:5] offset:2048
    global_load_dwordx4 v[112:115], v1, s[4:5] offset:3072
    s_mul_i32 s26, s67, 3320491
    s_add_u32 s27, s26, 3320491
    s_lshr_b32 s26, s26, 16
    s_lshr_b32 s27, s27, 16
    s_lshl_b32 s67, s60, 3
    s_mov_b32 s68, 4280423431
    s_mov_b32 s69, 2693902
    s_lshr_b64 s[68:69], s[68:69], s67
    s_and_b32 s68, s68, 255
    s_add_u32 s68, s68, s26
    s_min_u32 s27, s27, s68
    s_mov_b32 s68, 689638912
    s_mov_b32 s69, 2233351
    s_lshr_b64 s[68:69], s[68:69], s67
    s_and_b32 s68, s68, 255
    s_add_u32 s26, s26, s68
    s_add_u32 s26, s26, 208
    s_add_u32 s27, s27, 208
    v_lshrrev_b32 v9, 2, v0
    v_lshlrev_b32 v4, 2, v9
    v_add_u32 v9, 16, v9
    v_subrev_u32 v11, 26, v9
    v_min_u32 v9, v9, v11
    v_lshlrev_b32 v5, 2, v9
    s_add_u32 s69, s26, 0
    s_lshr_b32 s69, s69, 2
    s_add_u32 s69, s69, s63
    s_mul_i32 s69, s69, 104
    buffer_load_dword v6, v4, s[28:31], s69 offen
    buffer_load_dword v7, v5, s[28:31], s69 offen
    v_lshlrev_b32 v9, 3, v3
    buffer_load_dwordx2 v[84:85], v9, s[44:47], 0 offen offset:0
    buffer_load_dwordx2 v[86:87], v9, s[44:47], 0 offen offset:16
    buffer_load_dwordx2 v[88:89], v9, s[44:47], 0 offen offset:32
    buffer_load_dwordx2 v[90:91], v9, s[44:47], 0 offen offset:48
    s_barrier
    v_and_b32 v9, 3, v0
    v_lshlrev_b32 v13, 4, v9
    s_lshl_b32 s65, s60, 12
    s_add_u32 s65, s65, 49152
    s_mov_b32 s70, 0
    v_lshlrev_b32 v9, 1, v2
    v_add_u32 v9, s65, v9
    v_lshl_add_u32 v10, v3, 6, v9
    v_and_b32 v9, 31, v0
    v_mul_u32_u24 v12, 784, v9
    v_lshlrev_b32 v9, 4, v9
    v_add_u32 v9, 19968, v9
    v_min_u32 v12, v12, v9
    v_lshrrev_b32 v11, 5, v0
    v_lshl_add_u32 v12, v11, 4, v12
    v_mov_b32 v32, 0
    v_mov_b32 v33, 0
    v_mov_b32 v34, 0
    v_mov_b32 v35, 0
    v_mov_b32 v36, 0
    v_mov_b32 v37, 0
    v_mov_b32 v38, 0
    v_mov_b32 v39, 0
    v_mov_b32 v40, 0
    v_mov_b32 v41, 0
    v_mov_b32 v42, 0
    v_mov_b32 v43, 0
    v_mov_b32 v44, 0
    v_mov_b32 v45, 0
    v_mov_b32 v46, 0
    v_mov_b32 v47, 0
    v_mov_b32 v48, 0
    v_mov_b32 v49, 0
    v_mov_b32 v50, 0
    v_mov_b32 v51, 0
    v_mov_b32 v52, 0
    v_mov_b32 v53, 0
    v_mov_b32 v54, 0
    v_mov_b32 v55, 0
    v_mov_b32 v56, 0
    v_mov_b32 v57, 0
    v_mov_b32 v58, 0
    v_mov_b32 v59, 0
    v_mov_b32 v60, 0
    v_mov_b32 v61, 0
    v_mov_b32 v62, 0
    v_mov_b32 v63, 0
    v_mov_b32 v64, 0
    v_mov_b32 v65, 0
    v_mov_b32 v66, 0
    v_mov_b32 v67, 0
    v_mov_b32 v68, 0
    v_mov_b32 v69, 0
    v_mov_b32 v70, 0
    v_mov_b32 v71, 0
    v_mov_b32 v72, 0
    v_mov_b32 v73, 0
    v_mov_b32 v74, 0
    v_mov_b32 v75, 0
    v_mov_b32 v76, 0
    v_mov_b32 v77, 0
    v_mov_b32 v78, 0
    v_mov_b32 v79, 0
    v_mov_b32 v80, 0
    v_mov_b32 v81, 0
    v_mov_b32 v82, 0
    v_mov_b32 v83, 0
    v_lshlrev_b32 v92, 4, v3
    v_lshl_add_u32 v92, v2, 6, v92
    v_add_u32 v92, 81920, v92
    v_add_u32 v94, 83584, v94
    s_waitcnt vmcnt(10)
    s_mov_b64 exec, vcc
    ds_write_b16 v94, v95
    s_mov_b64 exec, -1
    v_lshl_or_b32 v140, v149, 16, v148
    v_lshl_or_b32 v141, v151, 16, v150
    v_lshl_or_b32 v142, v153, 16, v152
    v_lshl_or_b32 v143, v155, 16, v154
    v_lshl_or_b32 v144, v157, 16, v156
    v_lshl_or_b32 v145, v159, 16, v158
    v_lshl_or_b32 v146, v161, 16, v160
    v_lshl_or_b32 v147, v163, 16, v162
    s_waitcnt vmcnt(6)
    v_and_b32 v116, 0xffff0000, v100
    v_and_b32 v100, 0xffff, v100
    v_add_u32 v100, s66, v100
    v_and_b32 v117, 0xffff0000, v101
    v_and_b32 v101, 0xffff, v101
    v_add_u32 v101, s66, v101
    v_and_b32 v118, 0xffff0000, v102
    v_and_b32 v102, 0xffff, v102
    v_add_u32 v102, s66, v102
    v_and_b32 v119, 0xffff0000, v103
    v_and_b32 v103, 0xffff, v103
    v_add_u32 v103, s66, v103
    v_and_b32 v120, 0xffff0000, v104
    v_and_b32 v104, 0xffff, v104
    v_add_u32 v104, s66, v104
    v_and_b32 v121, 0xffff0000, v105
    v_and_b32 v105, 0xffff, v105
    v_add_u32 v105, s66, v105
    v_and_b32 v122, 0xffff0000, v106
    v_and_b32 v106, 0xffff, v106
    v_add_u32 v106, s66, v106
    v_and_b32 v123, 0xffff0000, v107
    v_and_b32 v107, 0xffff, v107
    v_add_u32 v107, s66, v107
    v_and_b32 v124, 0xffff0000, v108
    v_and_b32 v108, 0xffff, v108
    v_add_u32 v108, s66, v108
    v_and_b32 v125, 0xffff0000, v109
    v_and_b32 v109, 0xffff, v109
    v_add_u32 v109, s66, v109
    v_and_b32 v126, 0xffff0000, v110
    v_and_b32 v110, 0xffff, v110
    v_add_u32 v110, s66, v110
    v_and_b32 v127, 0xffff0000, v111
    v_and_b32 v111, 0xffff, v111
    v_add_u32 v111, s66, v111
    v_and_b32 v128, 0xffff0000, v112
    v_and_b32 v112, 0xffff, v112
    v_add_u32 v112, s66, v112
    v_and_b32 v129, 0xffff0000, v113
    v_and_b32 v113, 0xffff, v113
    v_add_u32 v113, s66, v113
L_spin_1:
    ds_read_b32 v94, v230 offset:44032
    s_waitcnt lgkmcnt(0)
    v_readfirstlane_b32 s69, v94
    s_cmp_ge_u32 s69, 6
    s_cbranch_scc1 L_spin_1d
    s_sleep 1
    s_branch L_spin_1
L_spin_1d:
    ds_read_b128 v[132:135], v92
    ds_read_b128 v[136:139], v92 offset:32
    s_waitcnt lgkmcnt(0)
    s_branch L_cmm
L_cw1:
    s_cmp_lt_u32 s60, 5
    s_cbranch_scc1 L_cplain
    s_sub_u32 s96, s2, 26
    s_cmp_eq_u32 s60, 6
    s_cbranch_scc1 L_cw1go
    s_add_u32 s96, s96, 22
    s_cmp_ge_u32 s96, 26
    s_cbranch_scc1 L_cplain
L_cw1go:
    s_getpc_b64 s[4:5]
    s_add_u32 s4, s4, cin_scatter_tab@rel32@lo+4
    s_addc_u32 s5, s5, cin_scatter_tab@rel32@hi+12
    v_cmp_gt_u32 vcc, 26, v2
    v_mov_b32 v93, 2146435072
    v_mov_b32 v164, 0
    v_mov_b32 v165, 0
    v_mov_b32 v166, 0
    v_mov_b32 v167, 0
    s_sub_u32 s66, s60, 5
    s_lshl_b32 s66, s66, 10
    s_add_u32 s66, s66, 83968
    v_add_u32 v14, s66, v1
    ds_write_b128 v14, v[164:167]
    v_mul_u32_u24 v92, 52, v2
    v_lshl_add_u32 v92, v3, 4, v92
    s_mul_i32 s69, s96, 1352
    v_cndmask_b32 v92, v93, v92, vcc
    buffer_load_dwordx4 v[140:143], v92, s[36:39], s69 offen offset:0
    buffer_load_dwordx4 v[144:147], v92, s[36:39], s69 offen offset:32
    global_load_dwordx4 v[100:103], v1, s[4:5] offset:0
    global_load_dwordx4 v[104:107], v1, s[4:5] offset:1024
    global_load_dwordx4 v[108:111], v1, s[4:5] offset:2048
    global_load_dwordx4 v[112:115], v1, s[4:5] offset:3072
    s_mul_i32 s26, s67, 3320491
    s_add_u32 s27, s26, 3320491
    s_lshr_b32 s26, s26, 16
    s_lshr_b32 s27, s27, 16
    s_lshl_b32 s67, s60, 3
    s_mov_b32 s68, 4280423431
    s_mov_b32 s69, 2693902
    s_lshr_b64 s[68:69], s[68:69], s67
    s_and_b32 s68, s68, 255
    s_add_u32 s68, s68, s26
    s_min_u32 s27, s27, s68
    s_mov_b32 s68, 689638912
    s_mov_b32 s69, 2233351
    s_lshr_b64 s[68:69], s[68:69], s67
    s_and_b32 s68, s68, 255
    s_add_u32 s26, s26, s68
    s_add_u32 s26, s26, 208
    s_add_u32 s27, s27, 208
    v_lshrrev_b32 v9, 2, v0
    v_lshlrev_b32 v4, 2, v9
    v_add_u32 v9, 16, v9
    v_subrev_u32 v11, 26, v9
    v_min_u32 v9, v9, v11
    v_lshlrev_b32 v5, 2, v9
    s_add_u32 s69, s26, 0
    s_lshr_b32 s69, s69, 2
    s_add_u32 s69, s69, s63
    s_mul_i32 s69, s69, 104
    buffer_load_dword v6, v4, s[28:31], s69 offen
    buffer_load_dword v7, v5, s[28:31], s69 offen
    v_lshlrev_b32 v9, 3, v3
    buffer_load_dwordx2 v[84:85], v9, s[44:47], 0 offen offset:0
    buffer_load_dwordx2 v[86:87], v9, s[44:47], 0 offen offset:16
    buffer_load_dwordx2 v[88:89], v9, s[44:47], 0 offen offset:32
    buffer_load_dwordx2 v[90:91], v9, s[44:47], 0 offen offset:48
    s_barrier
    v_and_b32 v9, 3, v0
    v_lshlrev_b32 v13, 4, v9
    s_lshl_b32 s65, s60, 12
    s_add_u32 s65, s65, 49152
    s_mov_b32 s70, 0
    v_lshlrev_b32 v9, 1, v2
    v_add_u32 v9, s65, v9
    v_lshl_add_u32 v10, v3, 6, v9
    v_and_b32 v9, 31, v0
    v_mul_u32_u24 v12, 784, v9
    v_lshlrev_b32 v9, 4, v9
    v_add_u32 v9, 19968, v9
    v_min_u32 v12, v12, v9
    v_lshrrev_b32 v11, 5, v0
    v_lshl_add_u32 v12, v11, 4, v12
    v_mov_b32 v32, 0
    v_mov_b32 v33, 0
    v_mov_b32 v34, 0
    v_mov_b32 v35, 0
    v_mov_b32 v36, 0
    v_mov_b32 v37, 0
    v_mov_b32 v38, 0
    v_mov_b32 v39, 0
    v_mov_b32 v40, 0
    v_mov_b32 v41, 0
    v_mov_b32 v42, 0
    v_mov_b32 v43, 0
    v_mov_b32 v44, 0
    v_mov_b32 v45, 0
    v_mov_b32 v46, 0
    v_mov_b32 v47, 0
    v_mov_b32 v48, 0
    v_mov_b32 v49, 0
    v_mov_b32 v50, 0
    v_mov_b32 v51, 0
    v_mov_b32 v52, 0
    v_mov_b32 v53, 0
    v_mov_b32 v54, 0
    v_mov_b32 v55, 0
    v_mov_b32 v56, 0
    v_mov_b32 v57, 0
    v_mov_b32 v58, 0
    v_mov_b32 v59, 0
    v_mov_b32 v60, 0
    v_mov_b32 v61, 0
    v_mov_b32 v62, 0
    v_mov_b32 v63, 0
    v_mov_b32 v64, 0
    v_mov_b32 v65, 0
    v_mov_b32 v66, 0
    v_mov_b32 v67, 0
    v_mov_b32 v68, 0
    v_mov_b32 v69, 0
    v_mov_b32 v70, 0
    v_mov_b32 v71, 0
    v_mov_b32 v72, 0
    v_mov_b32 v73, 0
    v_mov_b32 v74, 0
    v_mov_b32 v75, 0
    v_mov_b32 v76, 0
    v_mov_b32 v77, 0
    v_mov_b32 v78, 0
    v_mov_b32 v79, 0
    v_mov_b32 v80, 0
    v_mov_b32 v81, 0
    v_mov_b32 v82, 0
    v_mov_b32 v83, 0
    v_lshlrev_b32 v92, 3, v3
    v_sub_u32 v92, v2, v92
    v_mov_b32 v168, 0x3f80
    v_mov_b32 v169, 0x3f800000
    v_cndmask_b32 v92, -1, v92, vcc
    v_cmp_eq_u32 vcc, 0, v92
    v_cmp_eq_u32 s[68:69], 1, v92
    s_nop 0
    v_cndmask_b32 v132, 0, v168, vcc
    v_cndmask_b32 v132, v132, v169, s[68:69]
    v_cmp_eq_u32 vcc, 2, v92
    v_cmp_eq_u32 s[68:69], 3, v92
    s_nop 0
    v_cndmask_b32 v133, 0, v168, vcc
    v_cndmask_b32 v133, v133, v169, s[68:69]
    v_cmp_eq_u32 vcc, 4, v92
    v_cmp_eq_u32 s[68:69], 5, v92
    s_nop 0
    v_cndmask_b32 v134, 0, v168, vcc
    v_cndmask_b32 v134, v134, v169, s[68:69]
    v_cmp_eq_u32 vcc, 6, v92
    v_cmp_eq_u32 s[68:69], 7, v92
    s_nop 0
    v_cndmask_b32 v135, 0, v168, vcc
    v_cndmask_b32 v135, v135, v169, s[68:69]
    v_cmp_eq_u32 vcc, 16, v92
    v_cmp_eq_u32 s[68:69], 17, v92
    s_nop 0
    v_cndmask_b32 v136, 0, v168, vcc
    v_cndmask_b32 v136, v136, v169, s[68:69]
    v_cmp_eq_u32 vcc, 18, v92
    v_cmp_eq_u32 s[68:69], 19, v92
    s_nop 0
    v_cndmask_b32 v137, 0, v168, vcc
    v_cndmask_b32 v137, v137, v169, s[68:69]
    v_cmp_eq_u32 vcc, 20, v92
    v_cmp_eq_u32 s[68:69], 21, v92
    s_nop 0
    v_cndmask_b32 v138, 0, v168, vcc
    v_cndmask_b32 v138, v138, v169, s[68:69]
    v_cmp_eq_u32 vcc, 22, v92
    v_cmp_eq_u32 s[68:69], 23, v92
    s_nop 0
    v_cndmask_b32 v139, 0, v168, vcc
    v_cndmask_b32 v139, v139, v169, s[68:69]
    s_waitcnt vmcnt(6)
    v_and_b32 v116, 0xffff0000, v100
    v_and_b32 v100, 0xffff, v100
    v_add_u32 v100, s66, v100
    v_and_b32 v117, 0xffff0000, v101
    v_and_b32 v101, 0xffff, v101
    v_add_u32 v101, s66, v101
    v_and_b32 v118, 0xffff0000, v102
    v_and_b32 v102, 0xffff, v102
    v_add_u32 v102, s66, v102
    v_and_b32 v119, 0xffff0000, v103
    v_and_b32 v103, 0xffff, v103
    v_add_u32 v103, s66, v103
    v_and_b32 v120, 0xffff0000, v104
    v_and_b32 v104, 0xffff, v104
    v_add_u32 v104, s66, v104
    v_and_b32 v121, 0xffff0000, v105
    v_and_b32 v105, 0xffff, v105
    v_add_u32 v105, s66, v105
    v_and_b32 v122, 0xffff0000, v106
    v_and_b32 v106, 0xffff, v106
    v_add_u32 v106, s66, v106
    v_and_b32 v123, 0xffff0000, v107
    v_and_b32 v107, 0xffff, v107
    v_add_u32 v107, s66, v107
    v_and_b32 v124, 0xffff0000, v108
    v_and_b32 v108, 0xffff, v108
    v_add_u32 v108, s66, v108
    v_and_b32 v125, 0xffff0000, v109
    v_and_b32 v109, 0xffff, v109
    v_add_u32 v109, s66, v109
    v_and_b32 v126, 0xffff0000, v110
    v_and_b32 v110, 0xffff, v110
    v_add_u32 v110, s66, v110
    v_and_b32 v127, 0xffff0000, v111
    v_and_b32 v111, 0xffff, v111
    v_add_u32 v111, s66, v111
    v_and_b32 v128, 0xffff0000, v112
    v_and_b32 v112, 0xffff, v112
    v_add_u32 v112, s66, v112
    v_and_b32 v129, 0xffff0000, v113
    v_and_b32 v113, 0xffff, v113
    v_add_u32 v113, s66, v113
L_cmm:
    v_mfma_f32_32x32x16_bf16 v[164:179], v[132:135], v[140:143], 0
    v_mfma_f32_32x32x16_bf16 v[164:179], v[136:139], v[144:147], v[164:179]
    v_mfma_f32_32x32x16_bf16 v[164:179], v[140:143], v[132:135], v[164:179]
    v_mfma_f32_32x32x16_bf16 v[164:179], v[144:147], v[136:139], v[164:179]
    s_lshl_b32 s96, s96, 10
    s_add_u32 s96, s96, 655360
    v_mov_b32 v93, 1
    s_cmp_lt_u32 s2, 40
    s_cbranch_scc1 L_cnzc
    s_mul_i32 s69, s61, 4352
    s_add_u32 s69, s69, 786432
    v_lshlrev_b32 v94, 2, v0
    buffer_store_dword v230, v94, s[48:51], s69 offen sc1
L_cnzc:
    s_nop 8
    v_mul_f32 v164, v164, v116
    v_mul_f32 v165, v165, v117
    v_mul_f32 v166, v166, v118
    v_mul_f32 v167, v167, v119
    v_mul_f32 v168, v168, v120
    v_mul_f32 v169, v169, v121
    v_mul_f32 v170, v170, v122
    v_mul_f32 v171, v171, v123
    v_mul_f32 v172, v172, v124
    v_mul_f32 v173, v173, v125
    v_mul_f32 v174, v174, v126
    v_mul_f32 v175, v175, v127
    v_mul_f32 v176, v176, v128
    v_mul_f32 v177, v177, v129
    v_cvt_pk_bf16_f32 v180, v164, v165
    v_cvt_pk_bf16_f32 v181, v166, v167
    v_cvt_pk_bf16_f32 v182, v168, v169
    v_cvt_pk_bf16_f32 v183, v170, v171
    v_cvt_pk_bf16_f32 v184, v172, v173
    v_cvt_pk_bf16_f32 v185, v174, v175
    v_cvt_pk_bf16_f32 v186, v176, v177
    ds_write_b16 v100, v180
    ds_write_b16_d16_hi v101, v180
    ds_write_b16 v102, v181
    ds_write_b16_d16_hi v103, v181
    ds_write_b16 v104, v182
    ds_write_b16_d16_hi v105, v182
    ds_write_b16 v106, v183
    ds_write_b16_d16_hi v107, v183
    ds_write_b16 v108, v184
    ds_write_b16_d16_hi v109, v184
    ds_write_b16 v110, v185
    ds_write_b16_d16_hi v111, v185
    ds_write_b16 v112, v186
    ds_write_b16_d16_hi v113, v186
    ds_read_b128 v[140:143], v14
    s_waitcnt lgkmcnt(0)
    buffer_store_dwordx4 v[140:143], v1, s[48:51], s96 offen sc1
    s_waitcnt vmcnt(0)
    s_mov_b64 exec, 1
    buffer_atomic_add v93, v230, s[52:55], 0 offen offset:32 sc0
    s_waitcnt vmcnt(0)
    v_readfirstlane_b32 s69, v93
    s_cmp_lg_u32 s69, 51
    s_cbranch_scc1 L_cnotlast
    buffer_store_dword v93, v230, s[52:55], 0 offen offset:128 sc1
L_cnotlast:
    s_mov_b64 exec, 1
    ds_add_u32 v230, v231 offset:44044
    s_mov_b64 exec, -1
    s_branch L_cp1b
L_cplain:
    s_mul_i32 s26, s67, 3320491
    s_add_u32 s27, s26, 3320491
    s_lshr_b32 s26, s26, 16
    s_lshr_b32 s27, s27, 16
    s_lshl_b32 s67, s60, 3
    s_mov_b32 s68, 4280423431
    s_mov_b32 s69, 2693902
    s_lshr_b64 s[68:69], s[68:69], s67
    s_and_b32 s68, s68, 255
    s_add_u32 s68, s68, s26
    s_min_u32 s27, s27, s68
    s_mov_b32 s68, 689638912
    s_mov_b32 s69, 2233351
    s_lshr_b64 s[68:69], s[68:69], s67
    s_and_b32 s68, s68, 255
    s_add_u32 s26, s26, s68
    s_add_u32 s26, s26, 208
    s_add_u32 s27, s27, 208
    v_lshrrev_b32 v9, 2, v0
    v_lshlrev_b32 v4, 2, v9
    v_add_u32 v9, 16, v9
    v_subrev_u32 v11, 26, v9
    v_min_u32 v9, v9, v11
    v_lshlrev_b32 v5, 2, v9
    s_add_u32 s69, s26, 0
    s_lshr_b32 s69, s69, 2
    s_add_u32 s69, s69, s63
    s_mul_i32 s69, s69, 104
    buffer_load_dword v6, v4, s[28:31], s69 offen
    buffer_load_dword v7, v5, s[28:31], s69 offen
    v_lshlrev_b32 v9, 3, v3
    buffer_load_dwordx2 v[84:85], v9, s[44:47], 0 offen offset:0
    buffer_load_dwordx2 v[86:87], v9, s[44:47], 0 offen offset:16
    buffer_load_dwordx2 v[88:89], v9, s[44:47], 0 offen offset:32
    buffer_load_dwordx2 v[90:91], v9, s[44:47], 0 offen offset:48
    s_barrier
    v_and_b32 v9, 3, v0
    v_lshlrev_b32 v13, 4, v9
    s_lshl_b32 s65, s60, 12
    s_add_u32 s65, s65, 49152
    s_mov_b32 s70, 0
    v_lshlrev_b32 v9, 1, v2
    v_add_u32 v9, s65, v9
    v_lshl_add_u32 v10, v3, 6, v9
    v_and_b32 v9, 31, v0
    v_mul_u32_u24 v12, 784, v9
    v_lshlrev_b32 v9, 4, v9
    v_add_u32 v9, 19968, v9
    v_min_u32 v12, v12, v9
    v_lshrrev_b32 v11, 5, v0
    v_lshl_add_u32 v12, v11, 4, v12
    v_mov_b32 v32, 0
    v_mov_b32 v33, 0
    v_mov_b32 v34, 0
    v_mov_b32 v35, 0
    v_mov_b32 v36, 0
    v_mov_b32 v37, 0
    v_mov_b32 v38, 0
    v_mov_b32 v39, 0
    v_mov_b32 v40, 0
    v_mov_b32 v41, 0
    v_mov_b32 v42, 0
    v_mov_b32 v43, 0
    v_mov_b32 v44, 0
    v_mov_b32 v45, 0
    v_mov_b32 v46, 0
    v_mov_b32 v47, 0
    v_mov_b32 v48, 0
    v_mov_b32 v49, 0
    v_mov_b32 v50, 0
    v_mov_b32 v51, 0
    v_mov_b32 v52, 0
    v_mov_b32 v53, 0
    v_mov_b32 v54, 0
    v_mov_b32 v55, 0
    v_mov_b32 v56, 0
    v_mov_b32 v57, 0
    v_mov_b32 v58, 0
    v_mov_b32 v59, 0
    v_mov_b32 v60, 0
    v_mov_b32 v61, 0
    v_mov_b32 v62, 0
    v_mov_b32 v63, 0
    v_mov_b32 v64, 0
    v_mov_b32 v65, 0
    v_mov_b32 v66, 0
    v_mov_b32 v67, 0
    v_mov_b32 v68, 0
    v_mov_b32 v69, 0
    v_mov_b32 v70, 0
    v_mov_b32 v71, 0
    v_mov_b32 v72, 0
    v_mov_b32 v73, 0
    v_mov_b32 v74, 0
    v_mov_b32 v75, 0
    v_mov_b32 v76, 0
    v_mov_b32 v77, 0
    v_mov_b32 v78, 0
    v_mov_b32 v79, 0
    v_mov_b32 v80, 0
    v_mov_b32 v81, 0
    v_mov_b32 v82, 0
    v_mov_b32 v83, 0
L_cp1:
    s_waitcnt vmcnt(0)
L_cp1b:
    v_lshl_add_u32 v8, v6, 8, v13
    v_lshl_add_u32 v9, v7, 8, v13
    s_add_u32 s69, s26, 0
    s_and_b32 s69, s69, 3
    s_lshl_b32 s69, s69, 6
    s_xor_b32 s68, s70, 0
    s_add_u32 m0, s68, s65
    s_nop 0
    buffer_load_dwordx4 v8, s[32:35], s69 offen lds
    s_add_u32 m0, m0, 1024
    s_nop 0
    buffer_load_dwordx4 v9, s[32:35], s69 offen lds
    s_nop 0
    s_add_u32 s69, s26, 1
    s_lshr_b32 s69, s69, 2
    s_add_u32 s69, s69, s63
    s_mul_i32 s69, s69, 104
    buffer_load_dword v6, v4, s[28:31], s69 offen
    buffer_load_dword v7, v5, s[28:31], s69 offen
    v_lshlrev_b32 v16, 16, v84
    v_and_b32 v17, 0xffff0000, v84
    v_lshlrev_b32 v18, 16, v85
    v_and_b32 v19, 0xffff0000, v85
    v_lshlrev_b32 v20, 16, v86
    v_and_b32 v21, 0xffff0000, v86
    v_lshlrev_b32 v22, 16, v87
    v_and_b32 v23, 0xffff0000, v87
    v_lshlrev_b32 v24, 16, v88
    v_and_b32 v25, 0xffff0000, v88
    v_lshlrev_b32 v26, 16, v89
    v_and_b32 v27, 0xffff0000, v89
    v_lshlrev_b32 v28, 16, v90
    v_and_b32 v29, 0xffff0000, v90
    v_lshlrev_b32 v30, 16, v91
    v_and_b32 v31, 0xffff0000, v91
    s_waitcnt vmcnt(0)
    v_mov_b32 v2, v10
    ds_read_u16_d16_hi v32, v2 offset:0
    ds_read_u16_d16_hi v33, v2 offset:64
    ds_read_u16_d16_hi v34, v2 offset:128
    ds_read_u16_d16_hi v35, v2 offset:192
    ds_read_u16_d16_hi v36, v2 offset:256
    ds_read_u16_d16_hi v37, v2 offset:320
    ds_read_u16_d16_hi v38, v2 offset:384
    ds_read_u16_d16_hi v39, v2 offset:448
    ds_read_u16_d16_hi v40, v2 offset:512
    ds_read_u16_d16_hi v41, v2 offset:576
    ds_read_u16_d16_hi v42, v2 offset:640
    ds_read_u16_d16_hi v43, v2 offset:704
    ds_read_u16_d16_hi v44, v2 offset:768
    ds_read_u16_d16_hi v45, v2 offset:832
    ds_read_u16_d16_hi v46, v2 offset:896
    ds_read_u16_d16_hi v47, v2 offset:960
    ds_read_u16_d16_hi v48, v2 offset:1024
    ds_read_u16_d16_hi v49, v2 offset:1088
    ds_read_u16_d16_hi v50, v2 offset:1152
    ds_read_u16_d16_hi v51, v2 offset:1216
    ds_read_u16_d16_hi v52, v2 offset:1280
    ds_read_u16_d16_hi v53, v2 offset:1344
    ds_read_u16_d16_hi v54, v2 offset:1408
    ds_read_u16_d16_hi v55, v2 offset:1472
    ds_read_u16_d16_hi v56, v2 offset:1536
    ds_read_u16_d16_hi v57, v2 offset:1600
    v_lshl_add_u32 v8, v6, 8, v13
    v_lshl_add_u32 v9, v7, 8, v13
    s_add_u32 s69, s26, 1
    s_and_b32 s69, s69, 3
    s_lshl_b32 s69, s69, 6
    s_xor_b32 s68, s70, 2048
    s_add_u32 m0, s68, s65
    s_nop 0
    buffer_load_dwordx4 v8, s[32:35], s69 offen lds
    s_add_u32 m0, m0, 1024
    s_nop 0
    buffer_load_dwordx4 v9, s[32:35], s69 offen lds
    s_nop 0
    s_add_u32 s69, s26, 2
    s_lshr_b32 s69, s69, 2
    s_add_u32 s69, s69, s63
    s_mul_i32 s69, s69, 104
    buffer_load_dword v6, v4, s[28:31], s69 offen
    buffer_load_dword v7, v5, s[28:31], s69 offen
    v_mov_b32 v3, 0
    s_cmp_lg_u32 s60, 0
    s_cbranch_scc1 L_cwaitf
    s_mov_b64 exec, 1
L_cpoll:
    buffer_load_dword v9, v3, s[52:55], 0 offen offset:128 sc1
    s_waitcnt vmcnt(0)
    v_readfirstlane_b32 s69, v9
    s_cmp_lg_u32 s69, 0
    s_cbranch_scc1 L_cpolled
    s_sleep 2
    s_branch L_cpoll
L_cpolled:
    s_mov_b64 exec, 1
    ds_add_u32 v230, v231 offset:44036
    s_mov_b64 exec, -1
L_cwaitf:
L_spin_2:
    ds_read_b32 v9, v230 offset:44036
    s_waitcnt lgkmcnt(0)
    v_readfirstlane_b32 s69, v9
    s_cmp_ge_u32 s69, 1
    s_cbranch_scc1 L_spin_2d
    s_sleep 1
    s_branch L_spin_2
L_spin_2d:
    s_mov_b32 exec_hi, 0xffff
    s_add_u32 s68, s60, 0
    s_mul_i32 s69, s68, 784
    s_cmp_ge_u32 s68, 26
    s_cselect_b32 s67, 848, 0
    s_add_u32 m0, s69, s67
    s_lshl_b32 s68, s68, 10
    s_add_u32 s68, s68, 655360
    buffer_load_dwordx4 v1, s[48:51], s68 offen sc1 lds
    s_add_u32 s68, s60, 7
    s_mul_i32 s69, s68, 784
    s_cmp_ge_u32 s68, 26
    s_cselect_b32 s67, 848, 0
    s_add_u32 m0, s69, s67
    s_lshl_b32 s68, s68, 10
    s_add_u32 s68, s68, 655360
    buffer_load_dwordx4 v1, s[48:51], s68 offen sc1 lds
    s_add_u32 s68, s60, 14
    s_mul_i32 s69, s68, 784
    s_cmp_ge_u32 s68, 26
    s_cselect_b32 s67, 848, 0
    s_add_u32 m0, s69, s67
    s_lshl_b32 s68, s68, 10
    s_add_u32 s68, s68, 655360
    buffer_load_dwordx4 v1, s[48:51], s68 offen sc1 lds
    s_add_u32 s68, s60, 21
    s_mul_i32 s69, s68, 784
    s_cmp_ge_u32 s68, 26
    s_cselect_b32 s67, 848, 0
    s_add_u32 m0, s69, s67
    s_lshl_b32 s68, s68, 10
    s_add_u32 s68, s68, 655360
    buffer_load_dwordx4 v1, s[48:51], s68 offen sc1 lds
    s_add_u32 s68, s60, 28
    s_mul_i32 s69, s68, 784
    s_cmp_ge_u32 s68, 26
    s_cselect_b32 s67, 848, 0
    s_add_u32 m0, s69, s67
    s_lshl_b32 s68, s68, 10
    s_add_u32 s68, s68, 655360
    buffer_load_dwordx4 v1, s[48:51], s68 offen sc1 lds
    s_add_u32 s68, s60, 35
    s_mul_i32 s69, s68, 784
    s_cmp_ge_u32 s68, 26
    s_cselect_b32 s67, 848, 0
    s_add_u32 m0, s69, s67
    s_lshl_b32 s68, s68, 10
    s_add_u32 s68, s68, 655360
    buffer_load_dwordx4 v1, s[48:51], s68 offen sc1 lds
    s_add_u32 s68, s60, 42
    s_mul_i32 s69, s68, 784
    s_cmp_ge_u32 s68, 26
    s_cselect_b32 s67, 848, 0
    s_add_u32 m0, s69, s67
    s_lshl_b32 s68, s68, 10
    s_add_u32 s68, s68, 655360
    buffer_load_dwordx4 v1, s[48:51], s68 offen sc1 lds
    s_cmp_ge_u32 s60, 3
    s_cbranch_scc1 L_cgot
    s_add_u32 s68, s60, 49
    s_mul_i32 s69, s68, 784
    s_cmp_ge_u32 s68, 26
    s_cselect_b32 s67, 848, 0
    s_add_u32 m0, s69, s67
    s_lshl_b32 s68, s68, 10
    s_add_u32 s68, s68, 655360
    buffer_load_dwordx4 v1, s[48:51], s68 offen sc1 lds
L_cgot:
    s_mov_b64 exec, -1
    s_waitcnt lgkmcnt(0)
    v_mul_f32 v92, v32, v32
    v_mul_f32 v93, v32, v33
    v_mul_f32 v94, v32, v34
    v_mul_f32 v95, v32, v35
    v_cvt_pk_bf16_f32 v84, v92, v93
    v_mul_f32 v96, v32, v36
    v_mul_f32 v97, v32, v37
    v_cvt_pk_bf16_f32 v85, v94, v95
    v_mul_f32 v98, v32, v38
    v_mul_f32 v99, v32, v39
    v_cvt_pk_bf16_f32 v86, v96, v97
    v_cvt_pk_bf16_f32 v87, v98, v99
    s_waitcnt vmcnt(0)
    s_mov_b64 exec, 1
    ds_add_u32 v230, v231 offset:44040
    s_mov_b64 exec, -1
L_spin_3:
    ds_read_b32 v9, v230 offset:44040
    s_waitcnt lgkmcnt(0)
    v_readfirstlane_b32 s69, v9
    s_cmp_ge_u32 s69, 7
    s_cbranch_scc1 L_spin_3d
    s_sleep 1
    s_branch L_spin_3
L_spin_3d:
    ds_read_b128 v[100:103], v12 offset:0
    ds_read_b128 v[104:107], v12 offset:21232
    ds_read_b128 v[108:111], v12 offset:32
    ds_read_b128 v[112:115], v12 offset:21264
    ds_read_b128 v[116:119], v12 offset:64
    ds_read_b128 v[120:123], v12 offset:21296
    s_mov_b32 s71, 1
L_cloop:
    s_setprio 1
    s_waitcnt lgkmcnt(4)
    v_mfma_f32_32x32x16_bf16 v[132:147], v[100:103], v[84:87], 0
    ds_read_b128 v[124:127], v12 offset:96
    v_mul_f32 v92, v32, v40
    v_mul_f32 v93, v32, v41
    v_mul_f32 v94, v32, v42
    v_mul_f32 v95, v32, v43
    v_cvt_pk_bf16_f32 v88, v92, v93
    v_mul_f32 v96, v32, v44
    v_mfma_f32_32x32x16_bf16 v[148:163], v[104:107], v[84:87], v[16:31]
    v_mul_f32 v97, v32, v45
    v_cvt_pk_bf16_f32 v89, v94, v95
    v_mul_f32 v98, v34, v34
    v_mul_f32 v99, v34, v35
    v_cvt_pk_bf16_f32 v90, v96, v97
    v_cvt_pk_bf16_f32 v91, v98, v99
    ds_read_b128 v[128:131], v12 offset:21328
    s_waitcnt lgkmcnt(4)
    v_mfma_f32_32x32x16_bf16 v[132:147], v[108:111], v[88:91], v[132:147]
    ds_read_b128 v[100:103], v12 offset:128
    v_mul_f32 v92, v34, v36
    v_mul_f32 v93, v34, v37
    v_mul_f32 v94, v34, v38
    v_mul_f32 v95, v34, v39
    v_cvt_pk_bf16_f32 v84, v92, v93
    v_mul_f32 v96, v34, v40
    v_mul_f32 v97, v34, v41
    v_cvt_pk_bf16_f32 v85, v94, v95
    v_mfma_f32_32x32x16_bf16 v[148:163], v[112:115], v[88:91], v[148:163]
    v_mul_f32 v98, v34, v42
    v_mul_f32 v99, v34, v43
    v_cvt_pk_bf16_f32 v86, v96, v97
    v_cvt_pk_bf16_f32 v87, v98, v99
    v_mul_f32 v196, v164, v180
    v_mul_f32 v197, v165, v181
    v_fmac_f32 v196, v166, v182
    ds_read_b128 v[104:107], v12 offset:21360
    s_waitcnt lgkmcnt(4)
    v_mfma_f32_32x32x16_bf16 v[132:147], v[116:119], v[84:87], v[132:147]
    ds_read_b128 v[108:111], v12 offset:160
    v_mul_f32 v92, v34, v44
    v_mul_f32 v93, v34, v45
    v_mul_f32 v94, v34, v46
    v_mul_f32 v95, v34, v47
    v_cvt_pk_bf16_f32 v88, v92, v93
    v_mul_f32 v96, v36, v36
    v_mul_f32 v97, v36, v37
    v_cvt_pk_bf16_f32 v89, v94, v95
    v_mfma_f32_32x32x16_bf16 v[148:163], v[120:123], v[84:87], v[148:163]
    v_mul_f32 v98, v36, v38
    v_mul_f32 v99, v36, v39
    v_cvt_pk_bf16_f32 v90, v96, v97
    v_cvt_pk_bf16_f32 v91, v98, v99
    v_fmac_f32 v197, v167, v183
    v_fmac_f32 v196, v168, v184
    v_fmac_f32 v197, v169, v185
    ds_read_b128 v[112:115], v12 offset:21392
    s_waitcnt lgkmcnt(4)
    v_mfma_f32_32x32x16_bf16 v[132:147], v[124:127], v[88:91], v[132:147]
    ds_read_b128 v[116:119], v12 offset:192
    v_mul_f32 v92, v36, v40
    v_mul_f32 v93, v36, v41
    v_mul_f32 v94, v36, v42
    v_mul_f32 v95, v36, v43
    v_cvt_pk_bf16_f32 v84, v92, v93
    v_mul_f32 v96, v36, v44
    v_mul_f32 v97, v36, v45
    v_cvt_pk_bf16_f32 v85, v94, v95
    v_mfma_f32_32x32x16_bf16 v[148:163], v[128:131], v[88:91], v[148:163]
    v_mul_f32 v98, v36, v46
    v_mul_f32 v99, v36, v47
    v_cvt_pk_bf16_f32 v86, v96, v97
    v_cvt_pk_bf16_f32 v87, v98, v99
    v_fmac_f32 v196, v170, v186
    v_fmac_f32 v197, v171, v187
    v_fmac_f32 v196, v172, v188
    ds_read_b128 v[120:123], v12 offset:21424
    s_waitcnt lgkmcnt(4)
    v_mfma_f32_32x32x16_bf16 v[132:147], v[100:103], v[84:87], v[132:147]
    ds_read_b128 v[124:127], v12 offset:224
    v_mul_f32 v92, v36, v48
    v_mul_f32 v93, v36, v49
    v_mul_f32 v94, v38, v38
    v_mul_f32 v95, v38, v39
    v_cvt_pk_bf16_f32 v88, v92, v93
    v_mul_f32 v96, v38, v40
    v_mul_f32 v97, v38, v41
    v_cvt_pk_bf16_f32 v89, v94, v95
    v_mfma_f32_32x32x16_bf16 v[148:163], v[104:107], v[84:87], v[148:163]
    v_mul_f32 v98, v38, v42
    v_mul_f32 v99, v38, v43
    v_cvt_pk_bf16_f32 v90, v96, v97
    v_cvt_pk_bf16_f32 v91, v98, v99
    v_fmac_f32 v197, v173, v189
    v_fmac_f32 v196, v174, v190
    v_fmac_f32 v197, v175, v191
    ds_read_b128 v[128:131], v12 offset:21456
    s_waitcnt lgkmcnt(4)
    v_mfma_f32_32x32x16_bf16 v[132:147], v[108:111], v[88:91], v[132:147]
    ds_read_b128 v[100:103], v12 offset:256
    v_mul_f32 v92, v38, v44
    v_mul_f32 v93, v38, v45
    v_mul_f32 v94, v38, v46
    v_mul_f32 v95, v38, v47
    v_cvt_pk_bf16_f32 v84, v92, v93
    v_mul_f32 v96, v38, v48
    v_mul_f32 v97, v38, v49
    v_cvt_pk_bf16_f32 v85, v94, v95
    v_mfma_f32_32x32x16_bf16 v[148:163], v[112:115], v[88:91], v[148:163]
    v_mul_f32 v98, v38, v50
    v_mul_f32 v99, v38, v51
    v_cvt_pk_bf16_f32 v86, v96, v97
    v_cvt_pk_bf16_f32 v87, v98, v99
    v_fmac_f32 v196, v176, v192
    v_fmac_f32 v197, v177, v193
    v_add_f32 v196, v196, v197
    ds_read_b128 v[104:107], v12 offset:21488
    s_waitcnt lgkmcnt(4)
    v_mfma_f32_32x32x16_bf16 v[132:147], v[116:119], v[84:87], v[132:147]
    ds_read_b128 v[108:111], v12 offset:288
    v_mul_f32 v92, v40, v40
    v_mul_f32 v93, v40, v41
    v_mul_f32 v94, v40, v42
    v_mul_f32 v95, v40, v43
    v_cvt_pk_bf16_f32 v88, v92, v93
    v_mul_f32 v96, v40, v44
    v_mul_f32 v97, v40, v45
    v_mfma_f32_32x32x16_bf16 v[148:163], v[120:123], v[84:87], v[148:163]
    v_cvt_pk_bf16_f32 v89, v94, v95
    v_mul_f32 v98, v40, v46
    v_mul_f32 v99, v40, v47
    v_cvt_pk_bf16_f32 v90, v96, v97
    v_cvt_pk_bf16_f32 v91, v98, v99
    v_add_f32_dpp v196, v196, v196 row_shr:1 row_mask:0xf bank_mask:0xf bound_ctrl:0
    ds_read_b128 v[112:115], v12 offset:21520
    s_waitcnt lgkmcnt(4)
    v_mfma_f32_32x32x16_bf16 v[132:147], v[124:127], v[88:91], v[132:147]
    ds_read_b128 v[116:119], v12 offset:320
    v_mul_f32 v92, v40, v48
    v_mul_f32 v93, v40, v49
    v_mul_f32 v94, v40, v50
    v_mul_f32 v95, v40, v51
    v_cvt_pk_bf16_f32 v84, v92, v93
    v_mul_f32 v96, v40, v52
    v_mul_f32 v97, v40, v53
    v_mfma_f32_32x32x16_bf16 v[148:163], v[128:131], v[88:91], v[148:163]
    v_cvt_pk_bf16_f32 v85, v94, v95
    v_mul_f32 v98, v42, v42
    v_mul_f32 v99, v42, v43
    v_cvt_pk_bf16_f32 v86, v96, v97
    v_cvt_pk_bf16_f32 v87, v98, v99
    v_add_f32_dpp v196, v196, v196 row_shr:2 row_mask:0xf bank_mask:0xf bound_ctrl:0
    ds_read_b128 v[120:123], v12 offset:21552
    s_waitcnt lgkmcnt(4)
    v_mfma_f32_32x32x16_bf16 v[132:147], v[100:103], v[84:87], v[132:147]
    ds_read_b128 v[124:127], v12 offset:352
    v_mul_f32 v92, v42, v44
    v_mul_f32 v93, v42, v45
    v_mul_f32 v94, v42, v46
    v_mul_f32 v95, v42, v47
    v_cvt_pk_bf16_f32 v88, v92, v93
    v_mul_f32 v96, v42, v48
    v_mul_f32 v97, v42, v49
    v_mfma_f32_32x32x16_bf16 v[148:163], v[104:107], v[84:87], v[148:163]
    v_cvt_pk_bf16_f32 v89, v94, v95
    v_mul_f32 v98, v42, v50
    v_mul_f32 v99, v42, v51
    v_cvt_pk_bf16_f32 v90, v96, v97
    v_cvt_pk_bf16_f32 v91, v98, v99
    v_add_f32_dpp v196, v196, v196 row_shr:4 row_mask:0xf bank_mask:0xf bound_ctrl:0
    ds_read_b128 v[128:131], v12 offset:21584
    s_waitcnt lgkmcnt(4)
    v_mfma_f32_32x32x16_bf16 v[132:147], v[108:111], v[88:91], v[132:147]
    ds_read_b128 v[100:103], v12 offset:384
    v_mul_f32 v92, v42, v52
    v_mul_f32 v93, v42, v53
    v_mul_f32 v94, v42, v54
    v_mul_f32 v95, v42, v55
    v_cvt_pk_bf16_f32 v84, v92, v93
    v_mul_f32 v96, v44, v44
    v_mul_f32 v97, v44, v45
    v_mfma_f32_32x32x16_bf16 v[148:163], v[112:115], v[88:91], v[148:163]
    v_cvt_pk_bf16_f32 v85, v94, v95
    v_mul_f32 v98, v44, v46
    v_mul_f32 v99, v44, v47
    v_cvt_pk_bf16_f32 v86, v96, v97
    v_cvt_pk_bf16_f32 v87, v98, v99
    v_add_f32_dpp v196, v196, v196 row_shr:8 row_mask:0xf bank_mask:0xf bound_ctrl:0
    ds_read_b128 v[104:107], v12 offset:21616
    s_waitcnt lgkmcnt(4)
    v_mfma_f32_32x32x16_bf16 v[132:147], v[116:119], v[84:87], v[132:147]
    ds_read_b128 v[108:111], v12 offset:416
    v_mul_f32 v92, v44, v48
    v_mul_f32 v93, v44, v49
    v_mul_f32 v94, v44, v50
    v_mul_f32 v95, v44, v51
    v_cvt_pk_bf16_f32 v88, v92, v93
    v_mul_f32 v96, v44, v52
    v_mul_f32 v97, v44, v53
    v_mfma_f32_32x32x16_bf16 v[148:163], v[120:123], v[84:87], v[148:163]
    v_cvt_pk_bf16_f32 v89, v94, v95
    v_mul_f32 v98, v44, v54
    v_mul_f32 v99, v44, v55
    v_cvt_pk_bf16_f32 v90, v96, v97
    v_cvt_pk_bf16_f32 v91, v98, v99
    v_add_f32_dpp v196, v196, v196 row_bcast:15 row_mask:0xa bank_mask:0xf
    ds_read_b128 v[112:115], v12 offset:21648
    s_waitcnt lgkmcnt(4)
    v_mfma_f32_32x32x16_bf16 v[132:147], v[124:127], v[88:91], v[132:147]
    ds_read_b128 v[116:119], v12 offset:448
    v_mul_f32 v92, v44, v56
    v_mul_f32 v93, v44, v57
    v_mul_f32 v94, v46, v46
    v_mul_f32 v95, v46, v47
    v_cvt_pk_bf16_f32 v84, v92, v93
    v_mul_f32 v96, v46, v48
    v_mul_f32 v97, v46, v49
    v_mfma_f32_32x32x16_bf16 v[148:163], v[128:131], v[88:91], v[148:163]
    v_cvt_pk_bf16_f32 v85, v94, v95
    v_mul_f32 v98, v46, v50
    v_mul_f32 v99, v46, v51
    v_cvt_pk_bf16_f32 v86, v96, v97
    v_cvt_pk_bf16_f32 v87, v98, v99
    v_add_f32_dpp v196, v196, v196 row_bcast:31 row_mask:0xc bank_mask:0xf
    ds_read_b128 v[120:123], v12 offset:21680
    s_setprio 0
    s_waitcnt lgkmcnt(4)
    v_mfma_f32_32x32x16_bf16 v[132:147], v[100:103], v[84:87], v[132:147]
    ds_read_b128 v[124:127], v12 offset:480
    v_mul_f32 v92, v46, v52
    v_mul_f32 v93, v46, v53
    v_mul_f32 v94, v46, v54
    v_mul_f32 v95, v46, v55
    v_cvt_pk_bf16_f32 v88, v92, v93
    v_mul_f32 v96, v46, v56
    v_mfma_f32_32x32x16_bf16 v[148:163], v[104:107], v[84:87], v[148:163]
    v_mul_f32 v97, v46, v57
    v_cvt_pk_bf16_f32 v89, v94, v95
    v_mul_f32 v98, v46, v32
    v_mul_f32 v99, v48, v48
    v_cvt_pk_bf16_f32 v90, v96, v97
    v_cvt_pk_bf16_f32 v91, v98, v99
    ds_read_b128 v[128:131], v12 offset:21712
    s_waitcnt vmcnt(0)
    s_xor_b32 s70, s70, 2048
    v_add_u32 v2, s70, v10
    ds_read_u16_d16_hi v58, v2 offset:0
    ds_read_u16_d16_hi v59, v2 offset:64
    ds_read_u16_d16_hi v60, v2 offset:128
    ds_read_u16_d16_hi v61, v2 offset:192
    s_waitcnt lgkmcnt(8)
    v_mfma_f32_32x32x16_bf16 v[132:147], v[108:111], v[88:91], v[132:147]
    ds_read_b128 v[100:103], v12 offset:512
    v_mul_f32 v92, v48, v49
    v_mul_f32 v93, v48, v50
    v_mul_f32 v94, v48, v51
    v_mul_f32 v95, v48, v52
    v_cvt_pk_bf16_f32 v84, v92, v93
    v_mul_f32 v96, v48, v53
    v_mfma_f32_32x32x16_bf16 v[148:163], v[112:115], v[88:91], v[148:163]
    v_mul_f32 v97, v48, v54
    v_cvt_pk_bf16_f32 v85, v94, v95
    v_mul_f32 v98, v48, v55
    v_mul_f32 v99, v48, v56
    v_cvt_pk_bf16_f32 v86, v96, v97
    v_cvt_pk_bf16_f32 v87, v98, v99
    ds_read_b128 v[104:107], v12 offset:21744
    ds_read_u16_d16_hi v62, v2 offset:256
    ds_read_u16_d16_hi v63, v2 offset:320
    ds_read_u16_d16_hi v64, v2 offset:384
    ds_read_u16_d16_hi v65, v2 offset:448
    v_lshl_add_u32 v8, v6, 8, v13
    v_lshl_add_u32 v9, v7, 8, v13
    s_add_u32 s69, s26, 2
    s_and_b32 s69, s69, 3
    s_lshl_b32 s69, s69, 6
    s_xor_b32 s68, s70, 2048
    s_add_u32 m0, s68, s65
    s_nop 0
    buffer_load_dwordx4 v8, s[32:35], s69 offen lds
    s_add_u32 m0, m0, 1024
    s_nop 0
    buffer_load_dwordx4 v9, s[32:35], s69 offen lds
    s_waitcnt lgkmcnt(12)
    v_mfma_f32_32x32x16_bf16 v[132:147], v[116:119], v[84:87], v[132:147]
    ds_read_b128 v[108:111], v12 offset:544
    v_mul_f32 v92, v48, v57
    v_mul_f32 v93, v48, v32
    v_mul_f32 v94, v48, v33
    v_mul_f32 v95, v48, v34
    v_cvt_pk_bf16_f32 v88, v92, v93
    v_mul_f32 v96, v50, v50
    v_mfma_f32_32x32x16_bf16 v[148:163], v[120:123], v[84:87], v[148:163]
    v_mul_f32 v97, v50, v51
    v_cvt_pk_bf16_f32 v89, v94, v95
    v_mul_f32 v98, v50, v52
    v_mul_f32 v99, v50, v53
    v_cvt_pk_bf16_f32 v90, v96, v97
    v_cvt_pk_bf16_f32 v91, v98, v99
    ds_read_b128 v[112:115], v12 offset:21776
    ds_read_u16_d16_hi v66, v2 offset:512
    ds_read_u16_d16_hi v67, v2 offset:576
    ds_read_u16_d16_hi v68, v2 offset:640
    ds_read_u16_d16_hi v69, v2 offset:704
    s_add_u32 s69, s26, 3
    s_lshr_b32 s69, s69, 2
    s_add_u32 s69, s69, s63
    s_mul_i32 s69, s69, 104
    buffer_load_dword v6, v4, s[28:31], s69 offen
    buffer_load_dword v7, v5, s[28:31], s69 offen
    s_waitcnt lgkmcnt(15)
    v_mfma_f32_32x32x16_bf16 v[132:147], v[124:127], v[88:91], v[132:147]
    ds_read_b128 v[116:119], v12 offset:576
    v_mul_f32 v92, v50, v54
    v_mul_f32 v93, v50, v55
    v_mul_f32 v94, v50, v56
    v_mul_f32 v95, v50, v57
    v_cvt_pk_bf16_f32 v84, v92, v93
    v_mul_f32 v96, v50, v32
    v_mfma_f32_32x32x16_bf16 v[148:163], v[128:131], v[88:91], v[148:163]
    v_mul_f32 v97, v50, v33
    v_cvt_pk_bf16_f32 v85, v94, v95
    v_mul_f32 v98, v50, v34
    v_mul_f32 v99, v50, v35
    v_cvt_pk_bf16_f32 v86, v96, v97
    v_cvt_pk_bf16_f32 v87, v98, v99
    ds_read_b128 v[120:123], v12 offset:21808
    s_cmp_eq_u32 s71, 1
    s_cbranch_scc1 L_nost_4
    s_sub_u32 s68, s26, 1
    s_and_b32 s69, s68, 3
    s_add_u32 s69, s69, 52
    s_lshl_b32 s69, s69, 7
    s_lshr_b32 s68, s68, 2
    s_add_u32 s69, s69, s68
    s_mul_i32 s68, s61, 28672
    s_lshl2_add_u32 s69, s69, s68
    s_mov_b32 exec_lo, 0
    s_mov_b32 exec_hi, 0x80000000
    buffer_store_dword v196, v3, s[48:51], s69 offen sc1
    s_mov_b64 exec, -1
L_nost_4:
    s_mov_b32 s71, 0
    ds_read_u16_d16_hi v70, v2 offset:768
    ds_read_u16_d16_hi v71, v2 offset:832
    ds_read_u16_d16_hi v72, v2 offset:896
    ds_read_u16_d16_hi v73, v2 offset:960
    s_waitcnt lgkmcnt(15)
    v_mfma_f32_32x32x16_bf16 v[132:147], v[100:103], v[84:87], v[132:147]
    ds_read_b128 v[124:127], v12 offset:608
    v_mul_f32 v92, v50, v36
    v_mul_f32 v93, v52, v52
    v_mul_f32 v94, v52, v53
    v_mul_f32 v95, v52, v54
    v_cvt_pk_bf16_f32 v88, v92, v93
    v_mul_f32 v96, v52, v55
    v_mfma_f32_32x32x16_bf16 v[148:163], v[104:107], v[84:87], v[148:163]
    v_mul_f32 v97, v52, v56
    v_cvt_pk_bf16_f32 v89, v94, v95
    v_mul_f32 v98, v52, v57
    v_mul_f32 v99, v52, v32
    v_cvt_pk_bf16_f32 v90, v96, v97
    v_cvt_pk_bf16_f32 v91, v98, v99
    ds_read_b128 v[128:131], v12 offset:21840
    ds_read_u16_d16_hi v74, v2 offset:1024
    ds_read_u16_d16_hi v75, v2 offset:1088
    ds_read_u16_d16_hi v76, v2 offset:1152
    ds_read_u16_d16_hi v77, v2 offset:1216
    s_waitcnt lgkmcnt(15)
    v_mfma_f32_32x32x16_bf16 v[132:147], v[108:111], v[88:91], v[132:147]
    ds_read_b128 v[100:103], v12 offset:640
    v_mul_f32 v92, v52, v33
    v_mul_f32 v93, v52, v34
    v_mul_f32 v94, v52, v35
    v_mul_f32 v95, v52, v36
    v_cvt_pk_bf16_f32 v84, v92, v93
    v_mul_f32 v96, v52, v37
    v_mfma_f32_32x32x16_bf16 v[148:163], v[112:115], v[88:91], v[148:163]
    v_mul_f32 v97, v52, v38
    v_cvt_pk_bf16_f32 v85, v94, v95
    v_mul_f32 v98, v54, v54
    v_mul_f32 v99, v54, v55
    v_cvt_pk_bf16_f32 v86, v96, v97
    v_cvt_pk_bf16_f32 v87, v98, v99
    ds_read_b128 v[104:107], v12 offset:21872
    ds_read_u16_d16_hi v78, v2 offset:1280
    ds_read_u16_d16_hi v79, v2 offset:1344
    ds_read_u16_d16_hi v80, v2 offset:1408
    ds_read_u16_d16_hi v81, v2 offset:1472
    s_waitcnt lgkmcnt(15)
    v_mfma_f32_32x32x16_bf16 v[132:147], v[116:119], v[84:87], v[132:147]
    ds_read_b128 v[108:111], v12 offset:672
    v_mul_f32 v92, v54, v56
    v_mul_f32 v93, v54, v57
    v_mul_f32 v94, v54, v32
    v_mul_f32 v95, v54, v33
    v_cvt_pk_bf16_f32 v88, v92, v93
    v_mul_f32 v96, v54, v34
    v_mfma_f32_32x32x16_bf16 v[148:163], v[120:123], v[84:87], v[148:163]
    v_mul_f32 v97, v54, v35
    v_cvt_pk_bf16_f32 v89, v94, v95
    v_mul_f32 v98, v54, v36
    v_mul_f32 v99, v54, v37
    v_cvt_pk_bf16_f32 v90, v96, v97
    v_cvt_pk_bf16_f32 v91, v98, v99
    ds_read_b128 v[112:115], v12 offset:21904
    ds_read_u16_d16_hi v82, v2 offset:1536
    ds_read_u16_d16_hi v83, v2 offset:1600
    s_waitcnt lgkmcnt(14)
    v_mfma_f32_32x32x16_bf16 v[132:147], v[124:127], v[88:91], v[132:147]
    v_mul_f32 v92, v54, v38
    v_mul_f32 v93, v54, v39
    v_mul_f32 v94, v54, v40
    v_mul_f32 v95, v56, v56
    v_cvt_pk_bf16_f32 v84, v92, v93
    v_mul_f32 v96, v56, v57
    v_mfma_f32_32x32x16_bf16 v[148:163], v[128:131], v[88:91], v[148:163]
    v_mul_f32 v97, v56, v32
    v_cvt_pk_bf16_f32 v85, v94, v95
    v_mul_f32 v98, v56, v33
    v_mul_f32 v99, v56, v34
    v_cvt_pk_bf16_f32 v86, v96, v97
    v_cvt_pk_bf16_f32 v87, v98, v99
    ds_read_b128 v[120:123], v12 offset:21936
    s_waitcnt lgkmcnt(9)
    v_mfma_f32_32x32x16_bf16 v[132:147], v[100:103], v[84:87], v[132:147]
    v_mul_f32 v92, v56, v35
    v_mul_f32 v93, v56, v36
    v_mul_f32 v94, v56, v37
    v_mul_f32 v95, v56, v38
    v_cvt_pk_bf16_f32 v88, v92, v93
    v_mul_f32 v96, v56, v39
    v_mfma_f32_32x32x16_bf16 v[148:163], v[104:107], v[84:87], v[148:163]
    v_mul_f32 v97, v56, v40
    v_cvt_pk_bf16_f32 v89, v94, v95
    v_mul_f32 v98, v56, v41
    v_mul_f32 v99, v56, v42
    v_cvt_pk_bf16_f32 v90, v96, v97
    v_cvt_pk_bf16_f32 v91, v98, v99
    ds_read_b128 v[128:131], v12 offset:21968
    s_waitcnt lgkmcnt(4)
    v_mfma_f32_32x32x16_bf16 v[132:147], v[108:111], v[88:91], v[132:147]
    ds_read_b128 v[100:103], v12 offset:0
    v_cvt_pk_bf16_f32 v84, v32, v34
    v_cvt_pk_bf16_f32 v85, v36, v38
    v_mfma_f32_32x32x16_bf16 v[148:163], v[112:115], v[88:91], v[148:163]
    v_cvt_pk_bf16_f32 v86, v40, v42
    v_cvt_pk_bf16_f32 v87, v44, v46
    ds_read_b128 v[104:107], v12 offset:21232
    s_waitcnt lgkmcnt(3)
    v_mfma_f32_32x32x16_bf16 v[148:163], v[120:123], v[84:87], v[148:163]
    ds_read_b128 v[108:111], v12 offset:32
    v_cvt_pk_bf16_f32 v88, v48, v50
    v_cvt_pk_bf16_f32 v89, v52, v54
    v_cvt_pk_bf16_f32 v90, v56, v32
    v_cvt_pk_bf16_f32 v91, v32, v32
    ds_read_b128 v[112:115], v12 offset:21264
    s_waitcnt lgkmcnt(4)
    v_mfma_f32_32x32x16_bf16 v[148:163], v[128:131], v[88:91], v[148:163]
    ds_read_b128 v[116:119], v12 offset:64
    v_mul_f32 v92, v58, v58
    v_mul_f32 v93, v58, v59
    v_mul_f32 v94, v58, v60
    v_mul_f32 v95, v58, v61
    v_cvt_pk_bf16_f32 v84, v92, v93
    v_mul_f32 v96, v58, v62
    v_mul_f32 v97, v58, v63
    v_cvt_pk_bf16_f32 v85, v94, v95
    v_mul_f32 v98, v58, v64
    v_mul_f32 v99, v58, v65
    v_cvt_pk_bf16_f32 v86, v96, v97
    v_cvt_pk_bf16_f32 v87, v98, v99
    ds_read_b128 v[120:123], v12 offset:21296
    s_add_u32 s26, s26, 1
    s_cmp_lt_u32 s26, s27
    s_cbranch_scc0 L_cend0
    s_setprio 1
    s_waitcnt lgkmcnt(4)
    v_mfma_f32_32x32x16_bf16 v[164:179], v[100:103], v[84:87], 0
    ds_read_b128 v[124:127], v12 offset:96
    v_mul_f32 v92, v58, v66
    v_mul_f32 v93, v58, v67
    v_mul_f32 v94, v58, v68
    v_mul_f32 v95, v58, v69
    v_cvt_pk_bf16_f32 v88, v92, v93
    v_mul_f32 v96, v58, v70
    v_mfma_f32_32x32x16_bf16 v[180:195], v[104:107], v[84:87], v[16:31]
    v_mul_f32 v97, v58, v71
    v_cvt_pk_bf16_f32 v89, v94, v95
    v_mul_f32 v98, v60, v60
    v_mul_f32 v99, v60, v61
    v_cvt_pk_bf16_f32 v90, v96, v97
    v_cvt_pk_bf16_f32 v91, v98, v99
    ds_read_b128 v[128:131], v12 offset:21328
    s_waitcnt lgkmcnt(4)
    v_mfma_f32_32x32x16_bf16 v[164:179], v[108:111], v[88:91], v[164:179]
    ds_read_b128 v[100:103], v12 offset:128
    v_mul_f32 v92, v60, v62
    v_mul_f32 v93, v60, v63
    v_mul_f32 v94, v60, v64
    v_mul_f32 v95, v60, v65
    v_cvt_pk_bf16_f32 v84, v92, v93
    v_mul_f32 v96, v60, v66
    v_mul_f32 v97, v60, v67
    v_cvt_pk_bf16_f32 v85, v94, v95
    v_mfma_f32_32x32x16_bf16 v[180:195], v[112:115], v[88:91], v[180:195]
    v_mul_f32 v98, v60, v68
    v_mul_f32 v99, v60, v69
    v_cvt_pk_bf16_f32 v86, v96, v97
    v_cvt_pk_bf16_f32 v87, v98, v99
    v_mul_f32 v196, v132, v148
    v_mul_f32 v197, v133, v149
    v_fmac_f32 v196, v134, v150
    ds_read_b128 v[104:107], v12 offset:21360
    s_waitcnt lgkmcnt(4)
    v_mfma_f32_32x32x16_bf16 v[164:179], v[116:119], v[84:87], v[164:179]
    ds_read_b128 v[108:111], v12 offset:160
    v_mul_f32 v92, v60, v70
    v_mul_f32 v93, v60, v71
    v_mul_f32 v94, v60, v72
    v_mul_f32 v95, v60, v73
    v_cvt_pk_bf16_f32 v88, v92, v93
    v_mul_f32 v96, v62, v62
    v_mul_f32 v97, v62, v63
    v_cvt_pk_bf16_f32 v89, v94, v95
    v_mfma_f32_32x32x16_bf16 v[180:195], v[120:123], v[84:87], v[180:195]
    v_mul_f32 v98, v62, v64
    v_mul_f32 v99, v62, v65
    v_cvt_pk_bf16_f32 v90, v96, v97
    v_cvt_pk_bf16_f32 v91, v98, v99
    v_fmac_f32 v197, v135, v151
    v_fmac_f32 v196, v136, v152
    v_fmac_f32 v197, v137, v153
    ds_read_b128 v[112:115], v12 offset:21392
    s_waitcnt lgkmcnt(4)
    v_mfma_f32_32x32x16_bf16 v[164:179], v[124:127], v[88:91], v[164:179]
    ds_read_b128 v[116:119], v12 offset:192
    v_mul_f32 v92, v62, v66
    v_mul_f32 v93, v62, v67
    v_mul_f32 v94, v62, v68
    v_mul_f32 v95, v62, v69
    v_cvt_pk_bf16_f32 v84, v92, v93
    v_mul_f32 v96, v62, v70
    v_mul_f32 v97, v62, v71
    v_cvt_pk_bf16_f32 v85, v94, v95
    v_mfma_f32_32x32x16_bf16 v[180:195], v[128:131], v[88:91], v[180:195]
    v_mul_f32 v98, v62, v72
    v_mul_f32 v99, v62, v73
    v_cvt_pk_bf16_f32 v86, v96, v97
    v_cvt_pk_bf16_f32 v87, v98, v99
    v_fmac_f32 v196, v138, v154
    v_fmac_f32 v197, v139, v155
    v_fmac_f32 v196, v140, v156
    ds_read_b128 v[120:123], v12 offset:21424
    s_waitcnt lgkmcnt(4)
    v_mfma_f32_32x32x16_bf16 v[164:179], v[100:103], v[84:87], v[164:179]
    ds_read_b128 v[124:127], v12 offset:224
    v_mul_f32 v92, v62, v74
    v_mul_f32 v93, v62, v75
    v_mul_f32 v94, v64, v64
    v_mul_f32 v95, v64, v65
    v_cvt_pk_bf16_f32 v88, v92, v93
    v_mul_f32 v96, v64, v66
    v_mul_f32 v97, v64, v67
    v_cvt_pk_bf16_f32 v89, v94, v95
    v_mfma_f32_32x32x16_bf16 v[180:195], v[104:107], v[84:87], v[180:195]
    v_mul_f32 v98, v64, v68
    v_mul_f32 v99, v64, v69
    v_cvt_pk_bf16_f32 v90, v96, v97
    v_cvt_pk_bf16_f32 v91, v98, v99
    v_fmac_f32 v197, v141, v157
    v_fmac_f32 v196, v142, v158
    v_fmac_f32 v197, v143, v159
    ds_read_b128 v[128:131], v12 offset:21456
    s_waitcnt lgkmcnt(4)
    v_mfma_f32_32x32x16_bf16 v[164:179], v[108:111], v[88:91], v[164:179]
    ds_read_b128 v[100:103], v12 offset:256
    v_mul_f32 v92, v64, v70
    v_mul_f32 v93, v64, v71
    v_mul_f32 v94, v64, v72
    v_mul_f32 v95, v64, v73
    v_cvt_pk_bf16_f32 v84, v92, v93
    v_mul_f32 v96, v64, v74
    v_mul_f32 v97, v64, v75
    v_cvt_pk_bf16_f32 v85, v94, v95
    v_mfma_f32_32x32x16_bf16 v[180:195], v[112:115], v[88:91], v[180:195]
    v_mul_f32 v98, v64, v76
    v_mul_f32 v99, v64, v77
    v_cvt_pk_bf16_f32 v86, v96, v97
    v_cvt_pk_bf16_f32 v87, v98, v99
    v_fmac_f32 v196, v144, v160
    v_fmac_f32 v197, v145, v161
    v_add_f32 v196, v196, v197
    ds_read_b128 v[104:107], v12 offset:21488
    s_waitcnt lgkmcnt(4)
    v_mfma_f32_32x32x16_bf16 v[164:179], v[116:119], v[84:87], v[164:179]
    ds_read_b128 v[108:111], v12 offset:288
    v_mul_f32 v92, v66, v66
    v_mul_f32 v93, v66, v67
    v_mul_f32 v94, v66, v68
    v_mul_f32 v95, v66, v69
    v_cvt_pk_bf16_f32 v88, v92, v93
    v_mul_f32 v96, v66, v70
    v_mul_f32 v97, v66, v71
    v_mfma_f32_32x32x16_bf16 v[180:195], v[120:123], v[84:87], v[180:195]
    v_cvt_pk_bf16_f32 v89, v94, v95
    v_mul_f32 v98, v66, v72
    v_mul_f32 v99, v66, v73
    v_cvt_pk_bf16_f32 v90, v96, v97
    v_cvt_pk_bf16_f32 v91, v98, v99
    v_add_f32_dpp v196, v196, v196 row_shr:1 row_mask:0xf bank_mask:0xf bound_ctrl:0
    ds_read_b128 v[112:115], v12 offset:21520
    s_waitcnt lgkmcnt(4)
    v_mfma_f32_32x32x16_bf16 v[164:179], v[124:127], v[88:91], v[164:179]
    ds_read_b128 v[116:119], v12 offset:320
    v_mul_f32 v92, v66, v74
    v_mul_f32 v93, v66, v75
    v_mul_f32 v94, v66, v76
    v_mul_f32 v95, v66, v77
    v_cvt_pk_bf16_f32 v84, v92, v93
    v_mul_f32 v96, v66, v78
    v_mul_f32 v97, v66, v79
    v_mfma_f32_32x32x16_bf16 v[180:195], v[128:131], v[88:91], v[180:195]
    v_cvt_pk_bf16_f32 v85, v94, v95
    v_mul_f32 v98, v68, v68
    v_mul_f32 v99, v68, v69
    v_cvt_pk_bf16_f32 v86, v96, v97
    v_cvt_pk_bf16_f32 v87, v98, v99
    v_add_f32_dpp v196, v196, v196 row_shr:2 row_mask:0xf bank_mask:0xf bound_ctrl:0
    ds_read_b128 v[120:123], v12 offset:21552
    s_waitcnt lgkmcnt(4)
    v_mfma_f32_32x32x16_bf16 v[164:179], v[100:103], v[84:87], v[164:179]
    ds_read_b128 v[124:127], v12 offset:352
    v_mul_f32 v92, v68, v70
    v_mul_f32 v93, v68, v71
    v_mul_f32 v94, v68, v72
    v_mul_f32 v95, v68, v73
    v_cvt_pk_bf16_f32 v88, v92, v93
    v_mul_f32 v96, v68, v74
    v_mul_f32 v97, v68, v75
    v_mfma_f32_32x32x16_bf16 v[180:195], v[104:107], v[84:87], v[180:195]
    v_cvt_pk_bf16_f32 v89, v94, v95
    v_mul_f32 v98, v68, v76
    v_mul_f32 v99, v68, v77
    v_cvt_pk_bf16_f32 v90, v96, v97
    v_cvt_pk_bf16_f32 v91, v98, v99
    v_add_f32_dpp v196, v196, v196 row_shr:4 row_mask:0xf bank_mask:0xf bound_ctrl:0
    ds_read_b128 v[128:131], v12 offset:21584
    s_waitcnt lgkmcnt(4)
    v_mfma_f32_32x32x16_bf16 v[164:179], v[108:111], v[88:91], v[164:179]
    ds_read_b128 v[100:103], v12 offset:384
    v_mul_f32 v92, v68, v78
    v_mul_f32 v93, v68, v79
    v_mul_f32 v94, v68, v80
    v_mul_f32 v95, v68, v81
    v_cvt_pk_bf16_f32 v84, v92, v93
    v_mul_f32 v96, v70, v70
    v_mul_f32 v97, v70, v71
    v_mfma_f32_32x32x16_bf16 v[180:195], v[112:115], v[88:91], v[180:195]
    v_cvt_pk_bf16_f32 v85, v94, v95
    v_mul_f32 v98, v70, v72
    v_mul_f32 v99, v70, v73
    v_cvt_pk_bf16_f32 v86, v96, v97
    v_cvt_pk_bf16_f32 v87, v98, v99
    v_add_f32_dpp v196, v196, v196 row_shr:8 row_mask:0xf bank_mask:0xf bound_ctrl:0
    ds_read_b128 v[104:107], v12 offset:21616
    s_waitcnt lgkmcnt(4)
    v_mfma_f32_32x32x16_bf16 v[164:179], v[116:119], v[84:87], v[164:179]
    ds_read_b128 v[108:111], v12 offset:416
    v_mul_f32 v92, v70, v74
    v_mul_f32 v93, v70, v75
    v_mul_f32 v94, v70, v76
    v_mul_f32 v95, v70, v77
    v_cvt_pk_bf16_f32 v88, v92, v93
    v_mul_f32 v96, v70, v78
    v_mul_f32 v97, v70, v79
    v_mfma_f32_32x32x16_bf16 v[180:195], v[120:123], v[84:87], v[180:195]
    v_cvt_pk_bf16_f32 v89, v94, v95
    v_mul_f32 v98, v70, v80
    v_mul_f32 v99, v70, v81
    v_cvt_pk_bf16_f32 v90, v96, v97
    v_cvt_pk_bf16_f32 v91, v98, v99
    v_add_f32_dpp v196, v196, v196 row_bcast:15 row_mask:0xa bank_mask:0xf
    ds_read_b128 v[112:115], v12 offset:21648
    s_waitcnt lgkmcnt(4)
    v_mfma_f32_32x32x16_bf16 v[164:179], v[124:127], v[88:91], v[164:179]
    ds_read_b128 v[116:119], v12 offset:448
    v_mul_f32 v92, v70, v82
    v_mul_f32 v93, v70, v83
    v_mul_f32 v94, v72, v72
    v_mul_f32 v95, v72, v73
    v_cvt_pk_bf16_f32 v84, v92, v93
    v_mul_f32 v96, v72, v74
    v_mul_f32 v97, v72, v75
    v_mfma_f32_32x32x16_bf16 v[180:195], v[128:131], v[88:91], v[180:195]
    v_cvt_pk_bf16_f32 v85, v94, v95
    v_mul_f32 v98, v72, v76
    v_mul_f32 v99, v72, v77
    v_cvt_pk_bf16_f32 v86, v96, v97
    v_cvt_pk_bf16_f32 v87, v98, v99
    v_add_f32_dpp v196, v196, v196 row_bcast:31 row_mask:0xc bank_mask:0xf
    ds_read_b128 v[120:123], v12 offset:21680
    s_setprio 0
    s_waitcnt lgkmcnt(4)
    v_mfma_f32_32x32x16_bf16 v[164:179], v[100:103], v[84:87], v[164:179]
    ds_read_b128 v[124:127], v12 offset:480
    v_mul_f32 v92, v72, v78
    v_mul_f32 v93, v72, v79
    v_mul_f32 v94, v72, v80
    v_mul_f32 v95, v72, v81
    v_cvt_pk_bf16_f32 v88, v92, v93
    v_mul_f32 v96, v72, v82
    v_mfma_f32_32x32x16_bf16 v[180:195], v[104:107], v[84:87], v[180:195]
    v_mul_f32 v97, v72, v83
    v_cvt_pk_bf16_f32 v89, v94, v95
    v_mul_f32 v98, v72, v58
    v_mul_f32 v99, v74, v74
    v_cvt_pk_bf16_f32 v90, v96, v97
    v_cvt_pk_bf16_f32 v91, v98, v99
    ds_read_b128 v[128:131], v12 offset:21712
    s_waitcnt vmcnt(0)
    s_xor_b32 s70, s70, 2048
    v_add_u32 v2, s70, v10
    ds_read_u16_d16_hi v32, v2 offset:0
    ds_read_u16_d16_hi v33, v2 offset:64
    ds_read_u16_d16_hi v34, v2 offset:128
    ds_read_u16_d16_hi v35, v2 offset:192
    s_waitcnt lgkmcnt(8)
    v_mfma_f32_32x32x16_bf16 v[164:179], v[108:111], v[88:91], v[164:179]
    ds_read_b128 v[100:103], v12 offset:512
    v_mul_f32 v92, v74, v75
    v_mul_f32 v93, v74, v76
    v_mul_f32 v94, v74, v77
    v_mul_f32 v95, v74, v78
    v_cvt_pk_bf16_f32 v84, v92, v93
    v_mul_f32 v96, v74, v79
    v_mfma_f32_32x32x16_bf16 v[180:195], v[112:115], v[88:91], v[180:195]
    v_mul_f32 v97, v74, v80
    v_cvt_pk_bf16_f32 v85, v94, v95
    v_mul_f32 v98, v74, v81
    v_mul_f32 v99, v74, v82
    v_cvt_pk_bf16_f32 v86, v96, v97
    v_cvt_pk_bf16_f32 v87, v98, v99
    ds_read_b128 v[104:107], v12 offset:21744
    ds_read_u16_d16_hi v36, v2 offset:256
    ds_read_u16_d16_hi v37, v2 offset:320
    ds_read_u16_d16_hi v38, v2 offset:384
    ds_read_u16_d16_hi v39, v2 offset:448
    v_lshl_add_u32 v8, v6, 8, v13
    v_lshl_add_u32 v9, v7, 8, v13
    s_add_u32 s69, s26, 2
    s_and_b32 s69, s69, 3
    s_lshl_b32 s69, s69, 6
    s_xor_b32 s68, s70, 2048
    s_add_u32 m0, s68, s65
    s_nop 0
    buffer_load_dwordx4 v8, s[32:35], s69 offen lds
    s_add_u32 m0, m0, 1024
    s_nop 0
    buffer_load_dwordx4 v9, s[32:35], s69 offen lds
    s_waitcnt lgkmcnt(12)
    v_mfma_f32_32x32x16_bf16 v[164:179], v[116:119], v[84:87], v[164:179]
    ds_read_b128 v[108:111], v12 offset:544
    v_mul_f32 v92, v74, v83
    v_mul_f32 v93, v74, v58
    v_mul_f32 v94, v74, v59
    v_mul_f32 v95, v74, v60
    v_cvt_pk_bf16_f32 v88, v92, v93
    v_mul_f32 v96, v76, v76
    v_mfma_f32_32x32x16_bf16 v[180:195], v[120:123], v[84:87], v[180:195]
    v_mul_f32 v97, v76, v77
    v_cvt_pk_bf16_f32 v89, v94, v95
    v_mul_f32 v98, v76, v78
    v_mul_f32 v99, v76, v79
    v_cvt_pk_bf16_f32 v90, v96, v97
    v_cvt_pk_bf16_f32 v91, v98, v99
    ds_read_b128 v[112:115], v12 offset:21776
    ds_read_u16_d16_hi v40, v2 offset:512
    ds_read_u16_d16_hi v41, v2 offset:576
    ds_read_u16_d16_hi v42, v2 offset:640
    ds_read_u16_d16_hi v43, v2 offset:704
    s_add_u32 s69, s26, 3
    s_lshr_b32 s69, s69, 2
    s_add_u32 s69, s69, s63
    s_mul_i32 s69, s69, 104
    buffer_load_dword v6, v4, s[28:31], s69 offen
    buffer_load_dword v7, v5, s[28:31], s69 offen
    s_waitcnt lgkmcnt(15)
    v_mfma_f32_32x32x16_bf16 v[164:179], v[124:127], v[88:91], v[164:179]
    ds_read_b128 v[116:119], v12 offset:576
    v_mul_f32 v92, v76, v80
    v_mul_f32 v93, v76, v81
    v_mul_f32 v94, v76, v82
    v_mul_f32 v95, v76, v83
    v_cvt_pk_bf16_f32 v84, v92, v93
    v_mul_f32 v96, v76, v58
    v_mfma_f32_32x32x16_bf16 v[180:195], v[128:131], v[88:91], v[180:195]
    v_mul_f32 v97, v76, v59
    v_cvt_pk_bf16_f32 v85, v94, v95
    v_mul_f32 v98, v76, v60
    v_mul_f32 v99, v76, v61
    v_cvt_pk_bf16_f32 v86, v96, v97
    v_cvt_pk_bf16_f32 v87, v98, v99
    ds_read_b128 v[120:123], v12 offset:21808
    s_cmp_eq_u32 s71, 1
    s_cbranch_scc1 L_nost_5
    s_sub_u32 s68, s26, 1
    s_and_b32 s69, s68, 3
    s_add_u32 s69, s69, 52
    s_lshl_b32 s69, s69, 7
    s_lshr_b32 s68, s68, 2
    s_add_u32 s69, s69, s68
    s_mul_i32 s68, s61, 28672
    s_lshl2_add_u32 s69, s69, s68
    s_mov_b32 exec_lo, 0
    s_mov_b32 exec_hi, 0x80000000
    buffer_store_dword v196, v3, s[48:51], s69 offen sc1
    s_mov_b64 exec, -1
L_nost_5:
    s_mov_b32 s71, 0
    ds_read_u16_d16_hi v44, v2 offset:768
    ds_read_u16_d16_hi v45, v2 offset:832
    ds_read_u16_d16_hi v46, v2 offset:896
    ds_read_u16_d16_hi v47, v2 offset:960
    s_waitcnt lgkmcnt(15)
    v_mfma_f32_32x32x16_bf16 v[164:179], v[100:103], v[84:87], v[164:179]
    ds_read_b128 v[124:127], v12 offset:608
    v_mul_f32 v92, v76, v62
    v_mul_f32 v93, v78, v78
    v_mul_f32 v94, v78, v79
    v_mul_f32 v95, v78, v80
    v_cvt_pk_bf16_f32 v88, v92, v93
    v_mul_f32 v96, v78, v81
    v_mfma_f32_32x32x16_bf16 v[180:195], v[104:107], v[84:87], v[180:195]
    v_mul_f32 v97, v78, v82
    v_cvt_pk_bf16_f32 v89, v94, v95
    v_mul_f32 v98, v78, v83
    v_mul_f32 v99, v78, v58
    v_cvt_pk_bf16_f32 v90, v96, v97
    v_cvt_pk_bf16_f32 v91, v98, v99
    ds_read_b128 v[128:131], v12 offset:21840
    ds_read_u16_d16_hi v48, v2 offset:1024
    ds_read_u16_d16_hi v49, v2 offset:1088
    ds_read_u16_d16_hi v50, v2 offset:1152
    ds_read_u16_d16_hi v51, v2 offset:1216
    s_waitcnt lgkmcnt(15)
    v_mfma_f32_32x32x16_bf16 v[164:179], v[108:111], v[88:91], v[164:179]
    ds_read_b128 v[100:103], v12 offset:640
    v_mul_f32 v92, v78, v59
    v_mul_f32 v93, v78, v60
    v_mul_f32 v94, v78, v61
    v_mul_f32 v95, v78, v62
    v_cvt_pk_bf16_f32 v84, v92, v93
    v_mul_f32 v96, v78, v63
    v_mfma_f32_32x32x16_bf16 v[180:195], v[112:115], v[88:91], v[180:195]
    v_mul_f32 v97, v78, v64
    v_cvt_pk_bf16_f32 v85, v94, v95
    v_mul_f32 v98, v80, v80
    v_mul_f32 v99, v80, v81
    v_cvt_pk_bf16_f32 v86, v96, v97
    v_cvt_pk_bf16_f32 v87, v98, v99
    ds_read_b128 v[104:107], v12 offset:21872
    ds_read_u16_d16_hi v52, v2 offset:1280
    ds_read_u16_d16_hi v53, v2 offset:1344
    ds_read_u16_d16_hi v54, v2 offset:1408
    ds_read_u16_d16_hi v55, v2 offset:1472
    s_waitcnt lgkmcnt(15)
    v_mfma_f32_32x32x16_bf16 v[164:179], v[116:119], v[84:87], v[164:179]
    ds_read_b128 v[108:111], v12 offset:672
    v_mul_f32 v92, v80, v82
    v_mul_f32 v93, v80, v83
    v_mul_f32 v94, v80, v58
    v_mul_f32 v95, v80, v59
    v_cvt_pk_bf16_f32 v88, v92, v93
    v_mul_f32 v96, v80, v60
    v_mfma_f32_32x32x16_bf16 v[180:195], v[120:123], v[84:87], v[180:195]
    v_mul_f32 v97, v80, v61
    v_cvt_pk_bf16_f32 v89, v94, v95
    v_mul_f32 v98, v80, v62
    v_mul_f32 v99, v80, v63
    v_cvt_pk_bf16_f32 v90, v96, v97
    v_cvt_pk_bf16_f32 v91, v98, v99
    ds_read_b128 v[112:115], v12 offset:21904
    ds_read_u16_d16_hi v56, v2 offset:1536
    ds_read_u16_d16_hi v57, v2 offset:1600
    s_waitcnt lgkmcnt(14)
    v_mfma_f32_32x32x16_bf16 v[164:179], v[124:127], v[88:91], v[164:179]
    v_mul_f32 v92, v80, v64
    v_mul_f32 v93, v80, v65
    v_mul_f32 v94, v80, v66
    v_mul_f32 v95, v82, v82
    v_cvt_pk_bf16_f32 v84, v92, v93
    v_mul_f32 v96, v82, v83
    v_mfma_f32_32x32x16_bf16 v[180:195], v[128:131], v[88:91], v[180:195]
    v_mul_f32 v97, v82, v58
    v_cvt_pk_bf16_f32 v85, v94, v95
    v_mul_f32 v98, v82, v59
    v_mul_f32 v99, v82, v60
    v_cvt_pk_bf16_f32 v86, v96, v97
    v_cvt_pk_bf16_f32 v87, v98, v99
    ds_read_b128 v[120:123], v12 offset:21936
    s_waitcnt lgkmcnt(9)
    v_mfma_f32_32x32x16_bf16 v[164:179], v[100:103], v[84:87], v[164:179]
    v_mul_f32 v92, v82, v61
    v_mul_f32 v93, v82, v62
    v_mul_f32 v94, v82, v63
    v_mul_f32 v95, v82, v64
    v_cvt_pk_bf16_f32 v88, v92, v93
    v_mul_f32 v96, v82, v65
    v_mfma_f32_32x32x16_bf16 v[180:195], v[104:107], v[84:87], v[180:195]
    v_mul_f32 v97, v82, v66
    v_cvt_pk_bf16_f32 v89, v94, v95
    v_mul_f32 v98, v82, v67
    v_mul_f32 v99, v82, v68
    v_cvt_pk_bf16_f32 v90, v96, v97
    v_cvt_pk_bf16_f32 v91, v98, v99
    ds_read_b128 v[128:131], v12 offset:21968
    s_waitcnt lgkmcnt(4)
    v_mfma_f32_32x32x16_bf16 v[164:179], v[108:111], v[88:91], v[164:179]
    ds_read_b128 v[100:103], v12 offset:0
    v_cvt_pk_bf16_f32 v84, v58, v60
    v_cvt_pk_bf16_f32 v85, v62, v64
    v_mfma_f32_32x32x16_bf16 v[180:195], v[112:115], v[88:91], v[180:195]
    v_cvt_pk_bf16_f32 v86, v66, v68
    v_cvt_pk_bf16_f32 v87, v70, v72
    ds_read_b128 v[104:107], v12 offset:21232
    s_waitcnt lgkmcnt(3)
    v_mfma_f32_32x32x16_bf16 v[180:195], v[120:123], v[84:87], v[180:195]
    ds_read_b128 v[108:111], v12 offset:32
    v_cvt_pk_bf16_f32 v88, v74, v76
    v_cvt_pk_bf16_f32 v89, v78, v80
    v_cvt_pk_bf16_f32 v90, v82, v58
    v_cvt_pk_bf16_f32 v91, v58, v58
    ds_read_b128 v[112:115], v12 offset:21264
    s_waitcnt lgkmcnt(4)
    v_mfma_f32_32x32x16_bf16 v[180:195], v[128:131], v[88:91], v[180:195]
    ds_read_b128 v[116:119], v12 offset:64
    v_mul_f32 v92, v32, v32
    v_mul_f32 v93, v32, v33
    v_mul_f32 v94, v32, v34
    v_mul_f32 v95, v32, v35
    v_cvt_pk_bf16_f32 v84, v92, v93
    v_mul_f32 v96, v32, v36
    v_mul_f32 v97, v32, v37
    v_cvt_pk_bf16_f32 v85, v94, v95
    v_mul_f32 v98, v32, v38
    v_mul_f32 v99, v32, v39
    v_cvt_pk_bf16_f32 v86, v96, v97
    v_cvt_pk_bf16_f32 v87, v98, v99
    ds_read_b128 v[120:123], v12 offset:21296
    s_add_u32 s26, s26, 1
    s_cmp_lt_u32 s26, s27
    s_cbranch_scc1 L_cloop
L_cend1:
    s_nop 7
    v_mul_f32 v196, v164, v180
    v_mul_f32 v197, v165, v181
    v_fmac_f32 v196, v166, v182
    v_fmac_f32 v197, v167, v183
    v_fmac_f32 v196, v168, v184
    v_fmac_f32 v197, v169, v185
    v_fmac_f32 v196, v170, v186
    v_fmac_f32 v197, v171, v187
    v_fmac_f32 v196, v172, v188
    v_fmac_f32 v197, v173, v189
    v_fmac_f32 v196, v174, v190
    v_fmac_f32 v197, v175, v191
    v_fmac_f32 v196, v176, v192
    v_fmac_f32 v197, v177, v193
    v_add_f32 v196, v196, v197
    s_nop 1
    v_add_f32_dpp v196, v196, v196 row_shr:1 row_mask:0xf bank_mask:0xf bound_ctrl:0
    s_nop 1
    v_add_f32_dpp v196, v196, v196 row_shr:2 row_mask:0xf bank_mask:0xf bound_ctrl:0
    s_nop 1
    v_add_f32_dpp v196, v196, v196 row_shr:4 row_mask:0xf bank_mask:0xf bound_ctrl:0
    s_nop 1
    v_add_f32_dpp v196, v196, v196 row_shr:8 row_mask:0xf bank_mask:0xf bound_ctrl:0
    s_nop 1
    v_add_f32_dpp v196, v196, v196 row_bcast:15 row_mask:0xa bank_mask:0xf
    s_nop 1
    v_add_f32_dpp v196, v196, v196 row_bcast:31 row_mask:0xc bank_mask:0xf
    s_sub_u32 s68, s26, 1
    s_and_b32 s69, s68, 3
    s_add_u32 s69, s69, 52
    s_lshl_b32 s69, s69, 7
    s_lshr_b32 s68, s68, 2
    s_add_u32 s69, s69, s68
    s_mul_i32 s68, s61, 28672
    s_lshl2_add_u32 s69, s69, s68
    s_mov_b32 exec_lo, 0
    s_mov_b32 exec_hi, 0x80000000
    buffer_store_dword v196, v3, s[48:51], s69 offen sc1
    s_mov_b64 exec, -1
    s_branch L_cdone
L_cend0:
    s_nop 7
    v_mul_f32 v196, v132, v148
    v_mul_f32 v197, v133, v149
    v_fmac_f32 v196, v134, v150
    v_fmac_f32 v197, v135, v151
    v_fmac_f32 v196, v136, v152
    v_fmac_f32 v197, v137, v153
    v_fmac_f32 v196, v138, v154
    v_fmac_f32 v197, v139, v155
    v_fmac_f32 v196, v140, v156
    v_fmac_f32 v197, v141, v157
    v_fmac_f32 v196, v142, v158
    v_fmac_f32 v197, v143, v159
    v_fmac_f32 v196, v144, v160
    v_fmac_f32 v197, v145, v161
    v_add_f32 v196, v196, v197
    s_nop 1
    v_add_f32_dpp v196, v196, v196 row_shr:1 row_mask:0xf bank_mask:0xf bound_ctrl:0
    s_nop 1
    v_add_f32_dpp v196, v196, v196 row_shr:2 row_mask:0xf bank_mask:0xf bound_ctrl:0
    s_nop 1
    v_add_f32_dpp v196, v196, v196 row_shr:4 row_mask:0xf bank_mask:0xf bound_ctrl:0
    s_nop 1
    v_add_f32_dpp v196, v196, v196 row_shr:8 row_mask:0xf bank_mask:0xf bound_ctrl:0
    s_nop 1
    v_add_f32_dpp v196, v196, v196 row_bcast:15 row_mask:0xa bank_mask:0xf
    s_nop 1
    v_add_f32_dpp v196, v196, v196 row_bcast:31 row_mask:0xc bank_mask:0xf
    s_sub_u32 s68, s26, 1
    s_and_b32 s69, s68, 3
    s_add_u32 s69, s69, 52
    s_lshl_b32 s69, s69, 7
    s_lshr_b32 s68, s68, 2
    s_add_u32 s69, s69, s68
    s_mul_i32 s68, s61, 28672
    s_lshl2_add_u32 s69, s69, s68
    s_mov_b32 exec_lo, 0
    s_mov_b32 exec_hi, 0x80000000
    buffer_store_dword v196, v3, s[48:51], s69 offen sc1
    s_mov_b64 exec, -1
L_cdone:
    s_waitcnt vmcnt(0) lgkmcnt(0)
    s_branch L_join
L_scout:
    v_mov_b32 v16, 0
    v_mov_b32 v17, 0
    v_mov_b32 v18, 0
    v_mov_b32 v19, 0
    v_add_u32 v2, 81920, v1
    ds_write_b128 v2, v[16:19]
    ds_write_b128 v2, v[16:19] offset:1024
    ds_write_b128 v1, v[16:19] offset:44032
    v_mov_b32 v16, 0
    v_mov_b32 v17, 0
    v_mov_b32 v18, 0
    v_mov_b32 v19, 0
    v_lshlrev_b32 v2, 4, v0
    v_add_u32 v2, 20384, v2
    s_mov_b32 exec_hi, 0x1fffff
    ds_write_b128 v2, v[16:19]
    ds_write_b128 v2, v[16:19] offset:21232
    s_mov_b64 exec, -1
    s_waitcnt lgkmcnt(0)
    s_barrier
    v_mov_b32 v230, 0
L_spin_6:
    ds_read_b32 v20, v230 offset:44044
    s_waitcnt lgkmcnt(0)
    v_readfirstlane_b32 s69, v20
    s_cmp_ge_u32 s69, 1
    s_cbranch_scc1 L_spin_6d
    s_sleep 1
    s_branch L_spin_6
L_spin_6d:
    v_lshrrev_b32 v2, 3, v0
    v_mul_u32_u24 v2, 6656, v2
    v_and_b32 v3, 7, v0
    v_lshl_add_u32 v2, v3, 7, v2
    s_mul_i32 s68, s66, 26
    s_lshr_b32 s68, s68, 3
    s_lshl_b32 s68, s68, 8
    s_add_u32 s67, s67, 64
    s_mul_i32 s67, s67, 53248
    s_add_u32 s68, s68, s67
    v_mov_b32 v230, 0
L_scw0:
    buffer_load_dword v16, v2, s[36:39], s68 offen
    s_add_u32 s68, s68, 319488
    buffer_load_dword v17, v2, s[36:39], s68 offen
    s_add_u32 s68, s68, 319488
    ds_read_b32 v20, v230 offset:44040
    s_waitcnt vmcnt(0) lgkmcnt(0)
    v_readfirstlane_b32 s69, v20
    s_cmp_lt_u32 s69, 7
    s_cbranch_scc1 L_scw0
L_scw:
    buffer_load_dword v16, v2, s[36:39], s68 offen
    s_add_u32 s68, s68, 319488
    buffer_load_dword v17, v2, s[36:39], s68 offen
    s_add_u32 s68, s68, 319488
    s_waitcnt vmcnt(2)
    s_cmp_lt_u32 s68, 22151168
    s_cbranch_scc1 L_scw
    s_branch L_scdone
L_scdone:
    s_waitcnt vmcnt(0)
    s_branch L_join
    s_endpgm
L_end:
    s_endpgm
.section .rodata,"a"
.p2align 6
.amdhsa_kernel standalone__deep_cross_xdeepfm__recsys_kernel
  .amdhsa_next_free_vgpr 256
  .amdhsa_next_free_sgpr 102
  .amdhsa_accum_offset 256
  .amdhsa_group_segment_fixed_size 0
  .amdhsa_kernarg_size 88
  .amdhsa_user_sgpr_count 2
  .amdhsa_user_sgpr_kernarg_segment_ptr 1
  .amdhsa_system_sgpr_workgroup_id_x 1
.end_amdhsa_kernel
.p2align 8
cin_scatter_tab:
.long 0x3f000000, 0x3f800300, 0x3f800300, 0x3f800300
.long 0x3f800002, 0x3f000010, 0x3f800304, 0x3f800304
.long 0x3f800004, 0x3f800012, 0x3f00002c, 0x3f800308
.long 0x3f800006, 0x3f800014, 0x3f80002e, 0x3f00003c
.long 0x3f800008, 0x3f800016, 0x3f800040, 0x3f80003e
.long 0x3f80000a, 0x3f800018, 0x3f800042, 0x3f800050
.long 0x3f80000c, 0x3f80001a, 0x3f800044, 0x3f800052
.long 0x3f80000e, 0x3f80001c, 0x3f800046, 0x3f800054
.long 0x3f800020, 0x3f80001e, 0x3f800048, 0x3f800056
.long 0x3f800022, 0x3f800030, 0x3f80004a, 0x3f800058
.long 0x3f800024, 0x3f800032, 0x3f80004c, 0x3f80005a
.long 0x3f800026, 0x3f800034, 0x3f80004e, 0x3f80005c
.long 0x3f800028, 0x3f800036, 0x3f800060, 0x3f80005e
.long 0x3f80002a, 0x3f800038, 0x3f800062, 0x3f800070
.long 0x3f8001ac, 0x3f80003a, 0x3f800064, 0x3f800072
.long 0x3f8001ba, 0x3f8001bc, 0x3f800066, 0x3f800074
.long 0x3f8001e2, 0x3f8001e4, 0x3f8001e6, 0x3f800076
.long 0x3f8001f0, 0x3f8001f2, 0x3f8001f4, 0x3f8001f6
.long 0x3f800208, 0x3f80020a, 0x3f80020c, 0x3f80020e
.long 0x3f800216, 0x3f800218, 0x3f80021a, 0x3f80021c
.long 0x3f80022e, 0x3f800240, 0x3f800242, 0x3f800244
.long 0x3f80023c, 0x3f80023e, 0x3f800250, 0x3f800252
.long 0x3f800264, 0x3f800266, 0x3f800268, 0x3f80026a
.long 0x3f800272, 0x3f800274, 0x3f800276, 0x3f800278
.long 0x3f80028a, 0x3f80028c, 0x3f80028e, 0x3f8002a0
.long 0x3f800298, 0x3f80029a, 0x3f80029c, 0x3f80029e
.long 0x3f8002c0, 0x3f8002d0, 0x3f8002c2, 0x3f8002d2
.long 0x3f80036c, 0x3f80036c, 0x3f80036c, 0x3f80036c
.long 0x3f800370, 0x3f800370, 0x3f800370, 0x3f800370
.long 0x3f800374, 0x3f800374, 0x3f800374, 0x3f800374
.long 0x3f800378, 0x3f800378, 0x3f800378, 0x3f800378
.long 0x3f80037c, 0x3f80037c, 0x3f80037c, 0x3f80037c
.long 0x3f800300, 0x3f800300, 0x3f800300, 0x3f800300
.long 0x3f800304, 0x3f800304, 0x3f800304, 0x3f800304
.long 0x3f800308, 0x3f800308, 0x3f800308, 0x3f800308
.long 0x3f80030c, 0x3f80030c, 0x3f80030c, 0x3f80030c
.long 0x3f000068, 0x3f800310, 0x3f800310, 0x3f800310
.long 0x3f80006a, 0x3f000078, 0x3f800314, 0x3f800314
.long 0x3f80006c, 0x3f80007a, 0x3f0000a4, 0x3f800318
.long 0x3f80006e, 0x3f80007c, 0x3f8000a6, 0x3f0000b4
.long 0x3f800080, 0x3f80007e, 0x3f8000a8, 0x3f8000b6
.long 0x3f800082, 0x3f800090, 0x3f8000aa, 0x3f8000b8
.long 0x3f800084, 0x3f800092, 0x3f8000ac, 0x3f8000ba
.long 0x3f800086, 0x3f800094, 0x3f8000ae, 0x3f8000bc
.long 0x3f800088, 0x3f800096, 0x3f8000c0, 0x3f8000be
.long 0x3f80008a, 0x3f800098, 0x3f8000c2, 0x3f8000d0
.long 0x3f80008c, 0x3f80009a, 0x3f8000c4, 0x3f8000d2
.long 0x3f80008e, 0x3f80009c, 0x3f8000c6, 0x3f8000d4
.long 0x3f8000a0, 0x3f80009e, 0x3f8000c8, 0x3f8000d6
.long 0x3f8000a2, 0x3f8000b0, 0x3f8000ca, 0x3f8000d8
.long 0x3f800220, 0x3f8000b2, 0x3f8000cc, 0x3f8000da
.long 0x3f80021e, 0x3f800230, 0x3f8000ce, 0x3f8000dc
.long 0x3f800246, 0x3f800248, 0x3f80024a, 0x3f8000de
.long 0x3f800254, 0x3f800256, 0x3f800258, 0x3f80025a
.long 0x3f80026c, 0x3f80026e, 0x3f800280, 0x3f800282
.long 0x3f80027a, 0x3f80027c, 0x3f80027e, 0x3f800290
.long 0x3f8002a2, 0x3f8002a4, 0x3f8002a6, 0x3f8002a8
.long 0x3f8002b0, 0x3f8002b2, 0x3f8002b4, 0x3f8002b6
.long 0x3f8002c4, 0x3f8002d4, 0x3f8002c6, 0x3f8002d6
.long 0x3f80036c, 0x3f80036c, 0x3f80036c, 0x3f80036c
.long 0x3f800370, 0x3f800370, 0x3f800370, 0x3f800370
.long 0x3f800374, 0x3f800374, 0x3f800374, 0x3f800374
.long 0x3f800378, 0x3f800378, 0x3f800378, 0x3f800378
.long 0x3f80037c, 0x3f80037c, 0x3f80037c, 0x3f80037c
.long 0x3f800300, 0x3f800300, 0x3f800300, 0x3f800300
.long 0x3f800304, 0x3f800304, 0x3f800304, 0x3f800304
.long 0x3f800308, 0x3f800308, 0x3f800308, 0x3f800308
.long 0x3f80030c, 0x3f80030c, 0x3f80030c, 0x3f80030c
.long 0x3f800310, 0x3f800310, 0x3f800310, 0x3f800310
.long 0x3f800314, 0x3f800314, 0x3f800314, 0x3f800314
.long 0x3f800318, 0x3f800318, 0x3f800318, 0x3f800318
.long 0x3f80031c, 0x3f80031c, 0x3f80031c, 0x3f80031c
.long 0x3f0000e0, 0x3f800320, 0x3f800320, 0x3f800320
.long 0x3f8000e2, 0x3f0000f0, 0x3f800324, 0x3f800324
.long 0x3f8000e4, 0x3f8000f2, 0x3f00010c, 0x3f800328
.long 0x3f8000e6, 0x3f8000f4, 0x3f80010e, 0x3f00011c
.long 0x3f8000e8, 0x3f8000f6, 0x3f800120, 0x3f80011e
.long 0x3f8000ea, 0x3f8000f8, 0x3f800122, 0x3f800130
.long 0x3f8000ec, 0x3f8000fa, 0x3f800124, 0x3f800132
.long 0x3f8000ee, 0x3f8000fc, 0x3f800126, 0x3f800134
.long 0x3f800100, 0x3f8000fe, 0x3f800128, 0x3f800136
.long 0x3f800102, 0x3f800110, 0x3f80012a, 0x3f800138
.long 0x3f800104, 0x3f800112, 0x3f80012c, 0x3f80013a
.long 0x3f800106, 0x3f800114, 0x3f80012e, 0x3f80013c
.long 0x3f800108, 0x3f800116, 0x3f800140, 0x3f80013e
.long 0x3f80010a, 0x3f800118, 0x3f800142, 0x3f800150
.long 0x3f800284, 0x3f80011a, 0x3f800144, 0x3f800152
.long 0x3f800292, 0x3f800294, 0x3f800146, 0x3f800154
.long 0x3f8002aa, 0x3f8002ac, 0x3f8002ae, 0x3f800156
.long 0x3f8002b8, 0x3f8002ba, 0x3f8002bc, 0x3f8002be
.long 0x3f8002c8, 0x3f8002d8, 0x3f8002ca, 0x3f8002da
.long 0x3f80036c, 0x3f80036c, 0x3f80036c, 0x3f80036c
.long 0x3f800370, 0x3f800370, 0x3f800370, 0x3f800370
.long 0x3f800374, 0x3f800374, 0x3f800374, 0x3f800374
.long 0x3f800378, 0x3f800378, 0x3f800378, 0x3f800378
.long 0x3f80037c, 0x3f80037c, 0x3f80037c, 0x3f80037c
.long 0x3f800300, 0x3f800300, 0x3f800300, 0x3f800300
.long 0x3f800304, 0x3f800304, 0x3f800304, 0x3f800304
.long 0x3f800308, 0x3f800308, 0x3f800308, 0x3f800308
.long 0x3f80030c, 0x3f80030c, 0x3f80030c, 0x3f80030c
.long 0x3f800310, 0x3f800310, 0x3f800310, 0x3f800310
.long 0x3f800314, 0x3f800314, 0x3f800314, 0x3f800314
.long 0x3f800318, 0x3f800318, 0x3f800318, 0x3f800318
.long 0x3f80031c, 0x3f80031c, 0x3f80031c, 0x3f80031c
.long 0x3f800320, 0x3f800320, 0x3f800320, 0x3f800320
.long 0x3f800324, 0x3f800324, 0x3f800324, 0x3f800324
.long 0x3f800328, 0x3f800328, 0x3f800328, 0x3f800328
.long 0x3f80032c, 0x3f80032c, 0x3f80032c, 0x3f80032c
.long 0x3f000148, 0x3f800330, 0x3f800330, 0x3f800330
.long 0x3f80014a, 0x3f000158, 0x3f800334, 0x3f800334
.long 0x3f80014c, 0x3f80015a, 0x3f000184, 0x3f800338
.long 0x3f80014e, 0x3f80015c, 0x3f800186, 0x3f000194
.long 0x3f800160, 0x3f80015e, 0x3f800188, 0x3f800196
.long 0x3f800162, 0x3f800170, 0x3f80018a, 0x3f800198
.long 0x3f800164, 0x3f800172, 0x3f80018c, 0x3f80019a
.long 0x3f800166, 0x3f800174, 0x3f80018e, 0x3f80019c
.long 0x3f800168, 0x3f800176, 0x3f8001a0, 0x3f80019e
.long 0x3f80016a, 0x3f800178, 0x3f8001a2, 0x3f8001b0
.long 0x3f80016c, 0x3f80017a, 0x3f8001a4, 0x3f8001b2
.long 0x3f80016e, 0x3f80017c, 0x3f8001a6, 0x3f8001b4
.long 0x3f800180, 0x3f80017e, 0x3f8001a8, 0x3f8001b6
.long 0x3f800182, 0x3f800190, 0x3f8001aa, 0x3f8001b8
.long 0x3f8002cc, 0x3f8002dc, 0x3f8002ce, 0x3f8002de
.long 0x3f80036c, 0x3f80036c, 0x3f80036c, 0x3f80036c
.long 0x3f800370, 0x3f800370, 0x3f800370, 0x3f800370
.long 0x3f800374, 0x3f800374, 0x3f800374, 0x3f800374
.long 0x3f800378, 0x3f800378, 0x3f800378, 0x3f800378
.long 0x3f80037c, 0x3f80037c, 0x3f80037c, 0x3f80037c
.long 0x3f800300, 0x3f800300, 0x3f800300, 0x3f800300
.long 0x3f800304, 0x3f800304, 0x3f800304, 0x3f800304
.long 0x3f800308, 0x3f800308, 0x3f800308, 0x3f800308
.long 0x3f80030c, 0x3f80030c, 0x3f80030c, 0x3f80030c
.long 0x3f800310, 0x3f800310, 0x3f800310, 0x3f800310
.long 0x3f800314, 0x3f800314, 0x3f800314, 0x3f800314
.long 0x3f800318, 0x3f800318, 0x3f800318, 0x3f800318
.long 0x3f80031c, 0x3f80031c, 0x3f80031c, 0x3f80031c
.long 0x3f800320, 0x3f800320, 0x3f800320, 0x3f800320
.long 0x3f800324, 0x3f800324, 0x3f800324, 0x3f800324
.long 0x3f800328, 0x3f800328, 0x3f800328, 0x3f800328
.long 0x3f80032c, 0x3f80032c, 0x3f80032c, 0x3f80032c
.long 0x3f800330, 0x3f800330, 0x3f800330, 0x3f800330
.long 0x3f800334, 0x3f800334, 0x3f800334, 0x3f800334
.long 0x3f800338, 0x3f800338, 0x3f800338, 0x3f800338
.long 0x3f80033c, 0x3f80033c, 0x3f80033c, 0x3f80033c
.long 0x3f0001ae, 0x3f800340, 0x3f800340, 0x3f800340
.long 0x3f8001c0, 0x3f0001be, 0x3f800344, 0x3f800344
.long 0x3f8001c2, 0x3f8001d0, 0x3f0001e8, 0x3f800348
.long 0x3f8001c4, 0x3f8001d2, 0x3f8001ea, 0x3f0001f8
.long 0x3f8001c6, 0x3f8001d4, 0x3f8001ec, 0x3f8001fa
.long 0x3f8001c8, 0x3f8001d6, 0x3f8001ee, 0x3f8001fc
.long 0x3f8001ca, 0x3f8001d8, 0x3f800200, 0x3f8001fe
.long 0x3f8001cc, 0x3f8001da, 0x3f800202, 0x3f800210
.long 0x3f8001ce, 0x3f8001dc, 0x3f800204, 0x3f800212
.long 0x3f8001e0, 0x3f8001de, 0x3f800206, 0x3f800214
.long 0x3f8002e0, 0x3f8002f0, 0x3f8002e2, 0x3f8002f2
.long 0x3f80036c, 0x3f80036c, 0x3f80036c, 0x3f80036c
.long 0x3f800370, 0x3f800370, 0x3f800370, 0x3f800370
.long 0x3f800374, 0x3f800374, 0x3f800374, 0x3f800374
.long 0x3f800378, 0x3f800378, 0x3f800378, 0x3f800378
.long 0x3f80037c, 0x3f80037c, 0x3f80037c, 0x3f80037c
.long 0x3f800300, 0x3f800300, 0x3f800300, 0x3f800300
.long 0x3f800304, 0x3f800304, 0x3f800304, 0x3f800304
.long 0x3f800308, 0x3f800308, 0x3f800308, 0x3f800308
.long 0x3f80030c, 0x3f80030c, 0x3f80030c, 0x3f80030c
.long 0x3f800310, 0x3f800310, 0x3f800310, 0x3f800310
.long 0x3f800314, 0x3f800314, 0x3f800314, 0x3f800314
.long 0x3f800318, 0x3f800318, 0x3f800318, 0x3f800318
.long 0x3f80031c, 0x3f80031c, 0x3f80031c, 0x3f80031c
.long 0x3f800320, 0x3f800320, 0x3f800320, 0x3f800320
.long 0x3f800324, 0x3f800324, 0x3f800324, 0x3f800324
.long 0x3f800328, 0x3f800328, 0x3f800328, 0x3f800328
.long 0x3f80032c, 0x3f80032c, 0x3f80032c, 0x3f80032c
.long 0x3f800330, 0x3f800330, 0x3f800330, 0x3f800330
.long 0x3f800334, 0x3f800334, 0x3f800334, 0x3f800334
.long 0x3f800338, 0x3f800338, 0x3f800338, 0x3f800338
.long 0x3f80033c, 0x3f80033c, 0x3f80033c, 0x3f80033c
.long 0x3f800340, 0x3f800340, 0x3f800340, 0x3f800340
.long 0x3f800344, 0x3f800344, 0x3f800344, 0x3f800344
.long 0x3f800348, 0x3f800348, 0x3f800348, 0x3f800348
.long 0x3f80034c, 0x3f80034c, 0x3f80034c, 0x3f80034c
.long 0x3f000222, 0x3f800350, 0x3f800350, 0x3f800350
.long 0x3f800224, 0x3f000232, 0x3f800354, 0x3f800354
.long 0x3f800226, 0x3f800234, 0x3f00024c, 0x3f800358
.long 0x3f800228, 0x3f800236, 0x3f80024e, 0x3f00025c
.long 0x3f80022a, 0x3f800238, 0x3f800260, 0x3f80025e
.long 0x3f80022c, 0x3f80023a, 0x3f800262, 0x3f800270
.long 0x3f8002e4, 0x3f8002f4, 0x3f8002e6, 0x3f8002f6
.long 0x3f80036c, 0x3f80036c, 0x3f80036c, 0x3f80036c
.long 0x3f800370, 0x3f800370, 0x3f800370, 0x3f800370
.long 0x3f800374, 0x3f800374, 0x3f800374, 0x3f800374
.long 0x3f800378, 0x3f800378, 0x3f800378, 0x3f800378
.long 0x3f80037c, 0x3f80037c, 0x3f80037c, 0x3f80037c
.long 0x3f800300, 0x3f800300, 0x00000000, 0x00000000
.long 0x3f800304, 0x3f800304, 0x00000000, 0x00000000
.long 0x3f800308, 0x3f800308, 0x00000000, 0x00000000
.long 0x3f80030c, 0x3f80030c, 0x00000000, 0x00000000
.long 0x3f800310, 0x3f800310, 0x00000000, 0x00000000
.long 0x3f800314, 0x3f800314, 0x00000000, 0x00000000
.long 0x3f800318, 0x3f800318, 0x00000000, 0x00000000
.long 0x3f80031c, 0x3f80031c, 0x00000000, 0x00000000
.long 0x3f800320, 0x3f800320, 0x00000000, 0x00000000
.long 0x3f800324, 0x3f800324, 0x00000000, 0x00000000
.long 0x3f800328, 0x3f800328, 0x00000000, 0x00000000
.long 0x3f80032c, 0x3f80032c, 0x00000000, 0x00000000
.long 0x3f800330, 0x3f800330, 0x00000000, 0x00000000
.long 0x3f800334, 0x3f800334, 0x00000000, 0x00000000
.long 0x3f800338, 0x3f800338, 0x00000000, 0x00000000
.long 0x3f80033c, 0x3f80033c, 0x00000000, 0x00000000
.long 0x3f800340, 0x3f800340, 0x00000000, 0x00000000
.long 0x3f800344, 0x3f800344, 0x00000000, 0x00000000
.long 0x3f800348, 0x3f800348, 0x00000000, 0x00000000
.long 0x3f80034c, 0x3f80034c, 0x00000000, 0x00000000
.long 0x3f800350, 0x3f800350, 0x00000000, 0x00000000
.long 0x3f800354, 0x3f800354, 0x00000000, 0x00000000
.long 0x3f800358, 0x3f800358, 0x00000000, 0x00000000
.long 0x3f80035c, 0x3f80035c, 0x00000000, 0x00000000
.long 0x3f000286, 0x3f800360, 0x00000000, 0x00000000
.long 0x3f800288, 0x3f000296, 0x00000000, 0x00000000
.long 0x3f8002e8, 0x3f8002f8, 0x00000000, 0x00000000
.long 0x3f80036c, 0x3f80036c, 0x00000000, 0x00000000
.long 0x3f800370, 0x3f800370, 0x00000000, 0x00000000
.long 0x3f800374, 0x3f800374, 0x00000000, 0x00000000
.long 0x3f800378, 0x3f800378, 0x00000000, 0x00000000
.long 0x3f80037c, 0x3f80037c, 0x00000000, 0x00000000
.long 0x3f800300, 0x3f800300, 0x00000000, 0x00000000
.long 0x3f800304, 0x3f800304, 0x00000000, 0x00000000
.long 0x3f800308, 0x3f800308, 0x00000000, 0x00000000
.long 0x3f80030c, 0x3f80030c, 0x00000000, 0x00000000
.long 0x3f800310, 0x3f800310, 0x00000000, 0x00000000
.long 0x3f800314, 0x3f800314, 0x00000000, 0x00000000
.long 0x3f800318, 0x3f800318, 0x00000000, 0x00000000
.long 0x3f80031c, 0x3f80031c, 0x00000000, 0x00000000
.long 0x3f800320, 0x3f800320, 0x00000000, 0x00000000
.long 0x3f800324, 0x3f800324, 0x00000000, 0x00000000
.long 0x3f800328, 0x3f800328, 0x00000000, 0x00000000
.long 0x3f80032c, 0x3f80032c, 0x00000000, 0x00000000
.long 0x3f800330, 0x3f800330, 0x00000000, 0x00000000
.long 0x3f800334, 0x3f800334, 0x00000000, 0x00000000
.long 0x3f800338, 0x3f800338, 0x00000000, 0x00000000
.long 0x3f80033c, 0x3f80033c, 0x00000000, 0x00000000
.long 0x3f800340, 0x3f800340, 0x00000000, 0x00000000
.long 0x3f800344, 0x3f800344, 0x00000000, 0x00000000
.long 0x3f800348, 0x3f800348, 0x00000000, 0x00000000
.long 0x3f80034c, 0x3f80034c, 0x00000000, 0x00000000
.long 0x3f800350, 0x3f800350, 0x00000000, 0x00000000
.long 0x3f800354, 0x3f800354, 0x00000000, 0x00000000
.long 0x3f800358, 0x3f800358, 0x00000000, 0x00000000
.long 0x3f80035c, 0x3f80035c, 0x00000000, 0x00000000
.long 0x3f800360, 0x3f800360, 0x00000000, 0x00000000
.long 0x3f800364, 0x3f800364, 0x00000000, 0x00000000
.long 0x3f800368, 0x3f800368, 0x00000000, 0x00000000
.long 0x3f80036c, 0x3f80036c, 0x00000000, 0x00000000
.long 0x3f800370, 0x3f800370, 0x00000000, 0x00000000
.long 0x3f800374, 0x3f800374, 0x00000000, 0x00000000
.long 0x3f800378, 0x3f800378, 0x00000000, 0x00000000
.long 0x3f80037c, 0x3f80037c, 0x00000000, 0x00000000
```
